```python
import torch

def _softmax(x, axis=-1):
    return torch.softmax(x, dim=axis)
def _gelu(x):
    return torch.nn.functional.gelu(x, approximate="tanh")
def _silu(x):
    return torch.nn.functional.silu(x)
def _sigmoid(x):
    return torch.sigmoid(x)
def _layernorm(x, axis=-1, eps=1e-5):
    m = x.mean(dim=axis, keepdim=True)
    v = x.var(dim=axis, keepdim=True, unbiased=False)
    return (x - m) / torch.sqrt(v + eps)
def _scatter_add(tgt, idx, src, axis=0):
    return tgt.clone().index_add_(axis, idx, src)
def _segment_sum(src, seg, n):
    out = torch.zeros((n,) + src.shape[1:], dtype=src.dtype)
    return out.index_add_(0, seg, src)
def _pad(x, pw):
    flat = tuple(v for pair in reversed(pw) for v in pair)
    return torch.nn.functional.pad(x, flat)

kernel_name = 'parallel_sum__linear_attn_block__dense_activation_relu__prompt'

def setup_inputs():

    _w = (lambda a: (lambda t: t.to(torch.bfloat16) if t.is_floating_point() else t)(torch.as_tensor(a)))
    def _A_setup():
        B, S, D = 1, 2048, 640
        return {
            "x": _w((lambda *s: torch.randn(*s, dtype=torch.bfloat16) * 0.05)(B, S, D)),
            "wqkv": _w((lambda *s: torch.randn(*s, dtype=torch.bfloat16) * 0.2)(D, 3 * D)),
            "wo": _w((lambda *s: torch.randn(*s, dtype=torch.bfloat16) * 0.2)(D, D)),
        }
    _A_in = _A_setup()

    def _B_setup():
        B, S, D, Dff = 1, 2048, 640, 1536
        return {
            "x": _w((lambda *s: torch.randn(*s, dtype=torch.bfloat16) * 0.05)(B, S, D)),
            "w1": _w((lambda *s: torch.randn(*s, dtype=torch.bfloat16) * 0.05)(D, Dff)),
            "w2": _w((lambda *s: torch.randn(*s, dtype=torch.bfloat16) * 0.05)(Dff, D)),
        }
    _B_in = _B_setup()

    return {
        "A_x": _A_in["x"],
        "A_wqkv": _A_in["wqkv"],
        "A_wo": _A_in["wo"],
        "B_x": _B_in["x"],
        "B_w1": _B_in["w1"],
        "B_w2": _B_in["w2"],
    }

def reference(A_x, A_wqkv, A_wo, B_x, B_w1, B_w2):
    def _A_ref(x, wqkv, wo):
        B, S, D = x.shape
        H = 32; Dh = D // H
        qkv = (lambda x, *d: x.permute(*d))((x @ wqkv).reshape(B, S, 3, H, Dh), 2, 0, 3, 1, 4)
        q, k, v = qkv[0], qkv[1], qkv[2]
        phi = lambda t: torch.where(t > 0, t + 1, torch.exp(t)) + 1e-6
        pq, pk = phi(q), phi(k)
        kv = torch.einsum("bhsd,bhse->bhde", pk, v)
        z = torch.einsum("bhsd->bhd", pk)
        num = torch.einsum("bhqd,bhde->bhqe", pq, kv)
        den = torch.einsum("bhqd,bhd->bhq", pq, z)[..., None] + 1e-6
        o = num / den
        return (lambda x, *d: x.permute(*d))(o, 0, 2, 1, 3).reshape(B, S, D) @ wo

    def _B_ref(x, w1, w2):
        h = torch.einsum("bsd,df->bsf", x, w1)
        zero = torch.zeros_like(h)
        h = torch.maximum(h, zero)
        return torch.einsum("bsf,fd->bsd", h, w2)

    x = A_x
    xn = _layernorm(x, axis=-1)
    return x + _A_ref(xn, A_wqkv, A_wo) + _B_ref(xn, B_w1, B_w2)
```

```asm
; @launch grid=(256,1,1) block=(512,1,1) lds=163840
.amdgcn_target "amdgcn-amd-amdhsa--gfx950"
.text
.globl parallel_sum__linear_attn_block__dense_activation_relu__prompt_kernel
.p2align 8
.type parallel_sum__linear_attn_block__dense_activation_relu__prompt_kernel,@function
parallel_sum__linear_attn_block__dense_activation_relu__prompt_kernel:
    s_cmp_ge_u32 s2, 256
    s_cbranch_scc1 L_exit
    s_load_dwordx4 s[4:7], s[0:1], 0
    s_load_dwordx4 s[8:11], s[0:1], 32
    s_load_dwordx4 s[12:15], s[0:1], 56
    s_load_dwordx2 s[16:17], s[0:1], 16
    s_load_dwordx2 s[18:19], s[0:1], 48
    v_lshrrev_b32 v1, 6, v0
    v_and_b32 v0, 63, v0
    v_readfirstlane_b32 s3, v1
    s_bfe_u32 s60, s2, 0x20001
    s_lshl_b32 s60, s60, 2
    s_bfe_u32 s61, s2, 0x20005
    s_or_b32 s44, s60, s61
    s_and_b32 s49, s2, 1
    s_lshr_b32 s46, s2, 7
    s_bfe_u32 s61, s2, 0x20003
    s_lshl_b32 s62, s49, 2
    s_or_b32 s45, s62, s61
    s_bfe_u32 s48, s2, 0x30003
    s_lshr_b32 s61, s2, 6
    s_or_b32 s60, s60, s61
    s_lshl_b32 s60, s60, 1
    s_or_b32 s47, s60, s49
    s_sub_u32 s50, s3, 4
    s_cmp_ge_u32 s3, 4
    s_cbranch_scc0 L_cons
    s_cmp_ge_u32 s3, 6
    s_cbranch_scc1 L_aux
    v_lshrrev_b32 v1, 3, v0
    v_and_b32 v2, 7, v0
    v_lshrrev_b32 v3, 4, v0
    v_xor_b32 v4, v2, v3
    v_lshlrev_b32 v4, 4, v4
    s_lshl_b32 s51, s50, 6
    v_add_u32 v5, s51, v1
    v_mul_u32_u24 v5, 1280, v5
    v_add_u32 v10, v5, v4
    v_add_u32 v11, 10240, v10
    v_xor_b32 v11, 64, v11
    v_add_u32 v12, 20480, v10
    v_add_u32 v13, 20480, v11
    s_lshl_b32 s51, s50, 5
    s_mul_i32 s52, s44, 163840
    s_mul_i32 s53, s45, 160
    v_and_b32 v6, 1, v3
    v_lshlrev_b32 v6, 2, v6
    v_xor_b32 v6, v2, v6
    v_add_u32 v7, s51, v1
    v_mul_u32_u24 v8, 3072, v7
    v_lshl_add_u32 v19, v6, 4, v8
    v_add_u32 v20, 24576, v19
    s_mul_i32 s54, s45, 384
    s_mul_i32 s56, s50, 79872
    s_mov_b32 s55, s56
    s_add_u32 s57, s56, 39936
    s_mov_b32 s58, 0
    s_cmp_eq_u32 s46, 0
    s_cbranch_scc1 L_ldA
    v_add_u32 v6, 0, v0
    v_mul_u32_u24 v7, 171, v6
    v_lshrrev_b32 v7, 11, v7
    v_mul_u32_u24 v8, 12, v7
    v_sub_u32 v6, v6, v8
    v_add_u32 v8, 4294967294, v6
    v_cmp_gt_u32 vcc, 10, v6
    v_add_u32 v7, s51, v7
    v_mul_u32_u24 v7, 3840, v7
    v_cndmask_b32 v6, v8, v6, vcc
    v_lshl_add_u32 v14, v6, 4, v7
    v_add_u32 v6, 64, v0
    v_mul_u32_u24 v7, 171, v6
    v_lshrrev_b32 v7, 11, v7
    v_mul_u32_u24 v8, 12, v7
    v_sub_u32 v6, v6, v8
    v_add_u32 v8, 4294967294, v6
    v_cmp_gt_u32 vcc, 10, v6
    v_add_u32 v7, s51, v7
    v_mul_u32_u24 v7, 3840, v7
    v_cndmask_b32 v6, v8, v6, vcc
    v_lshl_add_u32 v15, v6, 4, v7
    v_add_u32 v6, 128, v0
    v_mul_u32_u24 v7, 171, v6
    v_lshrrev_b32 v7, 11, v7
    v_mul_u32_u24 v8, 12, v7
    v_sub_u32 v6, v6, v8
    v_add_u32 v8, 4294967294, v6
    v_cmp_gt_u32 vcc, 10, v6
    v_add_u32 v7, s51, v7
    v_mul_u32_u24 v7, 3840, v7
    v_cndmask_b32 v6, v8, v6, vcc
    v_lshl_add_u32 v16, v6, 4, v7
    s_and_b32 s59, s2, 7
    s_mul_i32 s59, s59, 5
    s_lshr_b32 s59, s59, 2
    s_lshl_b32 s60, s59, 7
    s_add_u32 s52, s52, s60
    s_mul_i32 s60, s59, 245760
    s_add_u32 s53, s53, s60
    s_mul_i32 s60, s59, 196608
    s_add_u32 s54, s54, s60
    s_waitcnt lgkmcnt(0)
    s_mov_b32 s20, s4
    s_and_b32 s21, s5, 0xffff
    s_mov_b32 s22, 2621440
    s_mov_b32 s23, 0x20000
    s_mov_b32 s24, s6
    s_and_b32 s25, s7, 0xffff
    s_mov_b32 s26, 2457600
    s_mov_b32 s27, 0x20000
    s_mov_b32 s28, s8
    s_and_b32 s29, s9, 0xffff
    s_mov_b32 s30, 1966080
    s_mov_b32 s31, 0x20000
L_ldp_B:
    s_add_u32 s60, s52, 40960
    s_add_u32 s61, s53, 61440
    s_add_u32 s62, s54, 49152
    s_add_u32 m0, s55, 0
    s_nop 0
    buffer_load_dwordx4 v10, s[20:23], s52 offen lds
    s_add_u32 m0, s55, 1024
    s_nop 0
    buffer_load_dwordx4 v11, s[20:23], s52 offen lds
    s_add_u32 m0, s55, 2048
    s_nop 0
    buffer_load_dwordx4 v12, s[20:23], s52 offen lds
    s_add_u32 m0, s55, 3072
    s_nop 0
    buffer_load_dwordx4 v13, s[20:23], s52 offen lds
    s_add_u32 m0, s55, 4096
    s_nop 0
    buffer_load_dwordx4 v19, s[28:31], s54 offen lds
    s_add_u32 m0, s55, 5120
    s_nop 0
    buffer_load_dwordx4 v20, s[28:31], s54 offen lds
    s_add_u32 m0, s55, 6016
    s_nop 0
    buffer_load_dwordx4 v19, s[28:31], s54 offen offset:128 lds
    s_add_u32 m0, s55, 7040
    s_nop 0
    buffer_load_dwordx4 v20, s[28:31], s54 offen offset:128 lds
    s_add_u32 m0, s55, 7936
    s_nop 0
    buffer_load_dwordx4 v19, s[28:31], s54 offen offset:256 lds
    s_add_u32 m0, s55, 8960
    s_nop 0
    buffer_load_dwordx4 v20, s[28:31], s54 offen offset:256 lds
    s_add_u32 m0, s55, 10240
    s_nop 0
    buffer_load_dwordx4 v14, s[24:27], s53 offen lds
    s_add_u32 m0, s55, 11264
    s_nop 0
    buffer_load_dwordx4 v15, s[24:27], s53 offen lds
    s_add_u32 m0, s55, 12288
    s_nop 0
    buffer_load_dwordx4 v16, s[24:27], s53 offen lds
    s_cmp_eq_u32 s58, 1
    s_cbranch_scc0 L_mid_B
    s_waitcnt vmcnt(13)
    s_barrier
L_mid_B:
    s_add_u32 m0, s55, 39936
    s_nop 0
    buffer_load_dwordx4 v10, s[20:23], s60 offen lds
    s_add_u32 m0, s55, 40960
    s_nop 0
    buffer_load_dwordx4 v11, s[20:23], s60 offen lds
    s_add_u32 m0, s55, 41984
    s_nop 0
    buffer_load_dwordx4 v12, s[20:23], s60 offen lds
    s_add_u32 m0, s55, 43008
    s_nop 0
    buffer_load_dwordx4 v13, s[20:23], s60 offen lds
    s_add_u32 m0, s55, 44032
    s_nop 0
    buffer_load_dwordx4 v19, s[28:31], s62 offen lds
    s_add_u32 m0, s55, 45056
    s_nop 0
    buffer_load_dwordx4 v20, s[28:31], s62 offen lds
    s_add_u32 m0, s55, 45952
    s_nop 0
    buffer_load_dwordx4 v19, s[28:31], s62 offen offset:128 lds
    s_add_u32 m0, s55, 46976
    s_nop 0
    buffer_load_dwordx4 v20, s[28:31], s62 offen offset:128 lds
    s_add_u32 m0, s55, 47872
    s_nop 0
    buffer_load_dwordx4 v19, s[28:31], s62 offen offset:256 lds
    s_add_u32 m0, s55, 48896
    s_nop 0
    buffer_load_dwordx4 v20, s[28:31], s62 offen offset:256 lds
    s_add_u32 m0, s55, 50176
    s_nop 0
    buffer_load_dwordx4 v14, s[24:27], s61 offen lds
    s_add_u32 m0, s55, 51200
    s_nop 0
    buffer_load_dwordx4 v15, s[24:27], s61 offen lds
    s_add_u32 m0, s55, 52224
    s_nop 0
    buffer_load_dwordx4 v16, s[24:27], s61 offen lds
    s_add_u32 s54, s54, 196608
    s_add_u32 s52, s52, 128
    s_add_u32 s53, s53, 245760
    s_add_u32 s55, s55, 13312
    s_cmp_ge_u32 s55, s57
    s_cselect_b32 s55, s56, s55
    s_add_u32 s59, s59, 1
    s_cmp_eq_u32 s59, 10
    s_cbranch_scc0 L_nw_B
    s_sub_u32 s52, s52, 1280
    s_sub_u32 s53, s53, 2457600
    s_sub_u32 s54, s54, 1966080
L_nw_B:
    s_add_u32 s58, s58, 1
    s_cmp_eq_u32 s58, 2
    s_cbranch_scc1 L_nb_B
    s_waitcnt vmcnt(26)
    s_barrier
L_nb_B:
    s_cmp_eq_u32 s58, 10
    s_cbranch_scc1 L_ldend
    s_cmp_eq_u32 s58, 2
    s_cbranch_scc0 L_ldp_B
    v_mov_b32 v26, 162944
    s_mov_b32 s62, 0
L_sp_pkB:
    ds_read_b32 v4, v26 offset:56
    s_waitcnt lgkmcnt(0)
    v_readfirstlane_b32 s60, v4
    s_nop 0
    s_cmp_ge_u32 s60, 2
    s_cbranch_scc1 L_spd_pkB
    s_sleep 1
    s_add_u32 s62, s62, 1
    s_cmp_lt_u32 s62, 0x800000
    s_cbranch_scc1 L_sp_pkB
L_spd_pkB:
    s_branch L_ldp_B
L_ldA:
    v_add_u32 v6, 0, v0
    v_mul_u32_u24 v7, 205, v6
    v_lshrrev_b32 v7, 12, v7
    v_mul_u32_u24 v8, 20, v7
    v_sub_u32 v6, v6, v8
    v_add_u32 v8, 70, v6
    v_cmp_gt_u32 vcc, 10, v6
    v_add_u32 v7, s51, v7
    v_mul_u32_u24 v7, 3840, v7
    v_cndmask_b32 v6, v8, v6, vcc
    v_lshl_add_u32 v14, v6, 4, v7
    v_add_u32 v6, 64, v0
    v_mul_u32_u24 v7, 205, v6
    v_lshrrev_b32 v7, 12, v7
    v_mul_u32_u24 v8, 20, v7
    v_sub_u32 v6, v6, v8
    v_add_u32 v8, 70, v6
    v_cmp_gt_u32 vcc, 10, v6
    v_add_u32 v7, s51, v7
    v_mul_u32_u24 v7, 3840, v7
    v_cndmask_b32 v6, v8, v6, vcc
    v_lshl_add_u32 v15, v6, 4, v7
    v_add_u32 v6, 128, v0
    v_mul_u32_u24 v7, 205, v6
    v_lshrrev_b32 v7, 12, v7
    v_mul_u32_u24 v8, 20, v7
    v_sub_u32 v6, v6, v8
    v_add_u32 v8, 70, v6
    v_cmp_gt_u32 vcc, 10, v6
    v_add_u32 v7, s51, v7
    v_mul_u32_u24 v7, 3840, v7
    v_cndmask_b32 v6, v8, v6, vcc
    v_lshl_add_u32 v16, v6, 4, v7
    v_add_u32 v6, 192, v0
    v_mul_u32_u24 v7, 205, v6
    v_lshrrev_b32 v7, 12, v7
    v_mul_u32_u24 v8, 20, v7
    v_sub_u32 v6, v6, v8
    v_add_u32 v8, 70, v6
    v_cmp_gt_u32 vcc, 10, v6
    v_add_u32 v7, s51, v7
    v_mul_u32_u24 v7, 3840, v7
    v_cndmask_b32 v6, v8, v6, vcc
    v_lshl_add_u32 v17, v6, 4, v7
    v_add_u32 v6, 256, v0
    v_mul_u32_u24 v7, 205, v6
    v_lshrrev_b32 v7, 12, v7
    v_mul_u32_u24 v8, 20, v7
    v_sub_u32 v6, v6, v8
    v_add_u32 v8, 70, v6
    v_cmp_gt_u32 vcc, 10, v6
    v_add_u32 v7, s51, v7
    v_mul_u32_u24 v7, 3840, v7
    v_cndmask_b32 v6, v8, v6, vcc
    v_lshl_add_u32 v18, v6, 4, v7
    s_add_u32 s53, s53, 1280
    s_and_b32 s59, s2, 7
    s_mul_i32 s59, s59, 5
    s_lshr_b32 s59, s59, 2
    s_lshl_b32 s60, s59, 7
    s_add_u32 s52, s52, s60
    s_mul_i32 s60, s59, 245760
    s_add_u32 s53, s53, s60
    s_mul_i32 s60, s59, 196608
    s_add_u32 s54, s54, s60
    s_waitcnt lgkmcnt(0)
    s_mov_b32 s20, s4
    s_and_b32 s21, s5, 0xffff
    s_mov_b32 s22, 2621440
    s_mov_b32 s23, 0x20000
    s_mov_b32 s24, s6
    s_and_b32 s25, s7, 0xffff
    s_mov_b32 s26, 2457600
    s_mov_b32 s27, 0x20000
    s_mov_b32 s28, s8
    s_and_b32 s29, s9, 0xffff
    s_mov_b32 s30, 1966080
    s_mov_b32 s31, 0x20000
L_ldp_A:
    s_add_u32 s60, s52, 40960
    s_add_u32 s61, s53, 61440
    s_add_u32 s62, s54, 49152
    s_add_u32 m0, s55, 0
    s_nop 0
    buffer_load_dwordx4 v10, s[20:23], s52 offen lds
    s_add_u32 m0, s55, 1024
    s_nop 0
    buffer_load_dwordx4 v11, s[20:23], s52 offen lds
    s_add_u32 m0, s55, 2048
    s_nop 0
    buffer_load_dwordx4 v12, s[20:23], s52 offen lds
    s_add_u32 m0, s55, 3072
    s_nop 0
    buffer_load_dwordx4 v13, s[20:23], s52 offen lds
    s_add_u32 m0, s55, 4096
    s_nop 0
    buffer_load_dwordx4 v14, s[24:27], s53 offen lds
    s_add_u32 m0, s55, 5120
    s_nop 0
    buffer_load_dwordx4 v15, s[24:27], s53 offen lds
    s_add_u32 m0, s55, 6144
    s_nop 0
    buffer_load_dwordx4 v16, s[24:27], s53 offen lds
    s_add_u32 m0, s55, 7168
    s_nop 0
    buffer_load_dwordx4 v17, s[24:27], s53 offen lds
    s_add_u32 m0, s55, 8192
    s_nop 0
    buffer_load_dwordx4 v18, s[24:27], s53 offen lds
    s_cmp_eq_u32 s58, 1
    s_cbranch_scc0 L_mid_A
    s_waitcnt vmcnt(9)
    s_barrier
L_mid_A:
    s_add_u32 m0, s55, 39936
    s_nop 0
    buffer_load_dwordx4 v10, s[20:23], s60 offen lds
    s_add_u32 m0, s55, 40960
    s_nop 0
    buffer_load_dwordx4 v11, s[20:23], s60 offen lds
    s_add_u32 m0, s55, 41984
    s_nop 0
    buffer_load_dwordx4 v12, s[20:23], s60 offen lds
    s_add_u32 m0, s55, 43008
    s_nop 0
    buffer_load_dwordx4 v13, s[20:23], s60 offen lds
    s_add_u32 m0, s55, 44032
    s_nop 0
    buffer_load_dwordx4 v14, s[24:27], s61 offen lds
    s_add_u32 m0, s55, 45056
    s_nop 0
    buffer_load_dwordx4 v15, s[24:27], s61 offen lds
    s_add_u32 m0, s55, 46080
    s_nop 0
    buffer_load_dwordx4 v16, s[24:27], s61 offen lds
    s_add_u32 m0, s55, 47104
    s_nop 0
    buffer_load_dwordx4 v17, s[24:27], s61 offen lds
    s_add_u32 m0, s55, 48128
    s_nop 0
    buffer_load_dwordx4 v18, s[24:27], s61 offen lds
    s_add_u32 s54, s54, 196608
    s_add_u32 s52, s52, 128
    s_add_u32 s53, s53, 245760
    s_add_u32 s55, s55, 13312
    s_cmp_ge_u32 s55, s57
    s_cselect_b32 s55, s56, s55
    s_add_u32 s59, s59, 1
    s_cmp_eq_u32 s59, 10
    s_cbranch_scc0 L_nw_A
    s_sub_u32 s52, s52, 1280
    s_sub_u32 s53, s53, 2457600
    s_sub_u32 s54, s54, 1966080
L_nw_A:
    s_add_u32 s58, s58, 1
    s_cmp_eq_u32 s58, 2
    s_cbranch_scc1 L_nb_A
    s_waitcnt vmcnt(18)
    s_barrier
L_nb_A:
    s_cmp_eq_u32 s58, 10
    s_cbranch_scc1 L_ldend
    s_cmp_eq_u32 s58, 2
    s_cbranch_scc0 L_ldp_A
    v_mov_b32 v26, 162944
    s_mov_b32 s62, 0
L_sp_pkA:
    ds_read_b32 v4, v26 offset:56
    s_waitcnt lgkmcnt(0)
    v_readfirstlane_b32 s60, v4
    s_nop 0
    s_cmp_ge_u32 s60, 2
    s_cbranch_scc1 L_spd_pkA
    s_sleep 1
    s_add_u32 s62, s62, 1
    s_cmp_lt_u32 s62, 0x800000
    s_cbranch_scc1 L_sp_pkA
L_spd_pkA:
    s_branch L_ldp_A
L_ldend:
    s_waitcnt vmcnt(0)
    s_mov_b32 s32, s14
    s_and_b32 s33, s15, 0xffff
    s_mov_b32 s34, 14155776
    s_mov_b32 s35, 0x20000
    s_branch L_phase2
L_aux:
    v_lshrrev_b32 v1, 3, v0
    v_and_b32 v2, 7, v0
    v_lshrrev_b32 v3, 4, v0
    v_mul_u32_u24 v21, 1280, v1
    v_lshl_add_u32 v21, v2, 4, v21
    v_mov_b32 v26, 162944
    s_mov_b32 s64, 0xffff0000
    v_lshlrev_b32 v4, 2, v0
    v_add_u32 v5, 162944, v4
    v_mov_b64 v[8:9], 0
    v_mov_b64 v[10:11], 0
    s_mov_b32 exec_hi, 0
    ds_write_b32 v5, v8
    s_mov_b64 exec, -1
    s_lshl_b32 s70, s2, 1
    s_add_u32 s70, s70, s50
    s_sub_u32 s70, s70, 2
    s_mul_i32 s71, s50, 39936
    s_add_u32 s71, s71, 26624
    s_waitcnt lgkmcnt(0)
    s_mov_b32 s20, s4
    s_and_b32 s21, s5, 0xffff
    s_mov_b32 s22, 2621440
    s_mov_b32 s23, 0x20000
    s_mov_b32 s32, s14
    s_and_b32 s33, s15, 0xffff
    s_mov_b32 s34, 14155776
    s_mov_b32 s35, 0x20000
    s_mov_b32 s40, s12
    s_and_b32 s41, s13, 0xffff
    s_mov_b32 s42, 256
    s_mov_b32 s43, 0x20000
    s_barrier
    s_add_u32 s60, s70, 0
    s_mul_i32 s72, s60, 6554
    s_lshr_b32 s72, s72, 16
    s_mul_i32 s61, s72, 10
    s_sub_u32 s73, s60, s61
    s_mov_b32 s62, 819200
    s_cmp_lt_u32 s72, 48
    s_cselect_b32 s24, s10, s16
    s_cselect_b32 s25, s11, s17
    s_cselect_b32 s26, 1966080, s62
    s_cselect_b32 s62, 0, 48
    s_and_b32 s25, s25, 0xffff
    s_mov_b32 s27, 0x20000
    s_sub_u32 s60, s72, s62
    s_mul_i32 s60, s60, 40960
    s_lshl_b32 s61, s73, 7
    s_add_u32 s60, s60, s61
    s_add_u32 m0, s71, 0
    s_nop 0
    buffer_load_dwordx4 v21, s[24:27], s60 offen lds
    s_add_u32 s60, s60, 10240
    s_add_u32 m0, s71, 1024
    s_nop 0
    buffer_load_dwordx4 v21, s[24:27], s60 offen lds
    s_add_u32 s60, s60, 10240
    s_add_u32 m0, s71, 2048
    s_nop 0
    buffer_load_dwordx4 v21, s[24:27], s60 offen lds
    s_add_u32 s60, s60, 10240
    s_add_u32 m0, s71, 3072
    s_nop 0
    buffer_load_dwordx4 v21, s[24:27], s60 offen lds
    s_add_u32 s60, s70, 512
    s_mul_i32 s74, s60, 6554
    s_lshr_b32 s74, s74, 16
    s_mul_i32 s61, s74, 10
    s_sub_u32 s75, s60, s61
    s_cmp_ge_u32 s74, 68
    s_cbranch_scc1 L_pk_1
    s_mov_b32 s62, 819200
    s_cmp_lt_u32 s74, 48
    s_cselect_b32 s24, s10, s16
    s_cselect_b32 s25, s11, s17
    s_cselect_b32 s26, 1966080, s62
    s_cselect_b32 s62, 0, 48
    s_and_b32 s25, s25, 0xffff
    s_mov_b32 s27, 0x20000
    s_sub_u32 s60, s74, s62
    s_mul_i32 s60, s60, 40960
    s_lshl_b32 s61, s75, 7
    s_add_u32 s60, s60, s61
    s_add_u32 m0, s71, 4096
    s_nop 0
    buffer_load_dwordx4 v21, s[24:27], s60 offen lds
    s_add_u32 s60, s60, 10240
    s_add_u32 m0, s71, 5120
    s_nop 0
    buffer_load_dwordx4 v21, s[24:27], s60 offen lds
    s_add_u32 s60, s60, 10240
    s_add_u32 m0, s71, 6144
    s_nop 0
    buffer_load_dwordx4 v21, s[24:27], s60 offen lds
    s_add_u32 s60, s60, 10240
    s_add_u32 m0, s71, 7168
    s_nop 0
    buffer_load_dwordx4 v21, s[24:27], s60 offen lds
L_pk_1:
    v_lshrrev_b32 v4, 5, v0
    v_bfe_u32 v5, v0, 4, 1
    v_bfe_u32 v6, v0, 2, 2
    v_lshlrev_b32 v4, 4, v4
    v_lshl_add_u32 v4, v5, 2, v4
    v_add_u32 v4, v4, v6
    v_lshlrev_b32 v4, 7, v4
    v_and_b32 v5, 3, v0
    v_lshl_add_u32 v4, v5, 3, v4
    v_add_u32 v22, s71, v4
    v_lshlrev_b32 v23, 4, v0
    s_lshr_b32 s68, s2, 3
    s_bfe_u32 s69, s2, 0x20001
    s_cmp_eq_u32 s50, 3
    s_cbranch_scc1 L_ax_x
    s_mul_i32 s60, s68, 52
    s_lshr_b32 s60, s60, 8
    s_mul_i32 s61, s60, 5
    s_add_u32 s61, s61, s68
    s_mul_i32 s62, s49, 5
    s_add_u32 s61, s61, s62
    s_mul_i32 s62, s49, 12
    s_add_u32 s62, s62, s68
    s_add_u32 s62, s62, 15
    s_cmp_lt_u32 s68, 15
    s_cselect_b32 s59, s61, s62
    s_mov_b32 s63, 3072
    s_cselect_b32 s36, s6, s8
    s_cselect_b32 s37, s7, s9
    s_cselect_b32 s63, 3840, s63
    s_cselect_b32 s65, 0, 30
    s_and_b32 s37, s37, 0xffff
    s_mul_i32 s38, s63, 640
    s_cmp_lt_u32 s68, 27
    s_cselect_b32 s38, s38, 0
    s_cselect_b32 s59, s59, 60
    s_mov_b32 s39, 0x20000
    v_mul_u32_u24 v4, s63, v1
    v_lshl_add_u32 v4, v2, 4, v4
    s_sub_u32 s65, s59, s65
    s_lshl_b32 s65, s65, 7
    s_mul_i32 s66, s63, 160
    s_mul_i32 s66, s66, s69
    s_add_u32 s65, s65, s66
    s_lshl_b32 s63, s63, 3
    buffer_load_dwordx4 v[64:67], v4, s[36:39], s65 offen
    s_add_u32 s65, s65, s63
    buffer_load_dwordx4 v[68:71], v4, s[36:39], s65 offen
    s_add_u32 s65, s65, s63
    buffer_load_dwordx4 v[72:75], v4, s[36:39], s65 offen
    s_add_u32 s65, s65, s63
    buffer_load_dwordx4 v[76:79], v4, s[36:39], s65 offen
    s_add_u32 s65, s65, s63
    buffer_load_dwordx4 v[80:83], v4, s[36:39], s65 offen
    s_add_u32 s65, s65, s63
    buffer_load_dwordx4 v[84:87], v4, s[36:39], s65 offen
    s_add_u32 s65, s65, s63
    buffer_load_dwordx4 v[88:91], v4, s[36:39], s65 offen
    s_add_u32 s65, s65, s63
    buffer_load_dwordx4 v[92:95], v4, s[36:39], s65 offen
    s_add_u32 s65, s65, s63
    s_barrier
    s_waitcnt vmcnt(8)
    ds_read_b64_tr_b16 v[160:161], v22 offset:0
    ds_read_b64_tr_b16 v[162:163], v22 offset:1024
    ds_read_b64_tr_b16 v[164:165], v22 offset:32
    ds_read_b64_tr_b16 v[166:167], v22 offset:1056
    ds_read_b64_tr_b16 v[168:169], v22 offset:64
    ds_read_b64_tr_b16 v[170:171], v22 offset:1088
    ds_read_b64_tr_b16 v[172:173], v22 offset:96
    ds_read_b64_tr_b16 v[174:175], v22 offset:1120
    ds_read_b64_tr_b16 v[176:177], v22 offset:4096
    ds_read_b64_tr_b16 v[178:179], v22 offset:5120
    ds_read_b64_tr_b16 v[180:181], v22 offset:4128
    ds_read_b64_tr_b16 v[182:183], v22 offset:5152
    ds_read_b64_tr_b16 v[184:185], v22 offset:4160
    ds_read_b64_tr_b16 v[186:187], v22 offset:5184
    ds_read_b64_tr_b16 v[188:189], v22 offset:4192
    ds_read_b64_tr_b16 v[190:191], v22 offset:5216
    s_waitcnt lgkmcnt(0)
    v_mov_b32 v12, 1
    s_mov_b64 exec, 1
    ds_add_u32 v26, v12 offset:56
    s_mov_b64 exec, -1
    buffer_load_dwordx4 v[96:99], v4, s[36:39], s65 offen
    s_add_u32 s65, s65, s63
    buffer_load_dwordx4 v[100:103], v4, s[36:39], s65 offen
    s_add_u32 s65, s65, s63
    buffer_load_dwordx4 v[104:107], v4, s[36:39], s65 offen
    s_add_u32 s65, s65, s63
    buffer_load_dwordx4 v[108:111], v4, s[36:39], s65 offen
    s_add_u32 s65, s65, s63
    buffer_load_dwordx4 v[112:115], v4, s[36:39], s65 offen
    s_add_u32 s65, s65, s63
    buffer_load_dwordx4 v[116:119], v4, s[36:39], s65 offen
    s_add_u32 s65, s65, s63
    buffer_load_dwordx4 v[120:123], v4, s[36:39], s65 offen
    s_add_u32 s65, s65, s63
    buffer_load_dwordx4 v[124:127], v4, s[36:39], s65 offen
    s_add_u32 s65, s65, s63
    buffer_load_dwordx4 v[128:131], v4, s[36:39], s65 offen
    s_add_u32 s65, s65, s63
    buffer_load_dwordx4 v[132:135], v4, s[36:39], s65 offen
    s_add_u32 s65, s65, s63
    buffer_load_dwordx4 v[136:139], v4, s[36:39], s65 offen
    s_add_u32 s65, s65, s63
    buffer_load_dwordx4 v[140:143], v4, s[36:39], s65 offen
    s_branch L_ax_st
L_ax_x:
    s_lshl_b32 s60, s69, 1
    s_add_u32 s60, s60, s49
    s_lshl_b32 s60, s60, 5
    s_add_u32 s69, s60, s68
    s_mul_i32 s60, s69, 10240
    buffer_load_dwordx4 v[64:67], v21, s[20:23], s60 offen offset:0
    buffer_load_dwordx4 v[68:71], v21, s[20:23], s60 offen offset:128
    buffer_load_dwordx4 v[72:75], v21, s[20:23], s60 offen offset:256
    buffer_load_dwordx4 v[76:79], v21, s[20:23], s60 offen offset:384
    buffer_load_dwordx4 v[80:83], v21, s[20:23], s60 offen offset:512
    buffer_load_dwordx4 v[84:87], v21, s[20:23], s60 offen offset:640
    buffer_load_dwordx4 v[88:91], v21, s[20:23], s60 offen offset:768
    buffer_load_dwordx4 v[92:95], v21, s[20:23], s60 offen offset:896
    s_barrier
    s_waitcnt vmcnt(8)
    ds_read_b64_tr_b16 v[160:161], v22 offset:0
    ds_read_b64_tr_b16 v[162:163], v22 offset:1024
    ds_read_b64_tr_b16 v[164:165], v22 offset:32
    ds_read_b64_tr_b16 v[166:167], v22 offset:1056
    ds_read_b64_tr_b16 v[168:169], v22 offset:64
    ds_read_b64_tr_b16 v[170:171], v22 offset:1088
    ds_read_b64_tr_b16 v[172:173], v22 offset:96
    ds_read_b64_tr_b16 v[174:175], v22 offset:1120
    ds_read_b64_tr_b16 v[176:177], v22 offset:4096
    ds_read_b64_tr_b16 v[178:179], v22 offset:5120
    ds_read_b64_tr_b16 v[180:181], v22 offset:4128
    ds_read_b64_tr_b16 v[182:183], v22 offset:5152
    ds_read_b64_tr_b16 v[184:185], v22 offset:4160
    ds_read_b64_tr_b16 v[186:187], v22 offset:5184
    ds_read_b64_tr_b16 v[188:189], v22 offset:4192
    ds_read_b64_tr_b16 v[190:191], v22 offset:5216
    s_waitcnt lgkmcnt(0)
    v_mov_b32 v12, 1
    s_mov_b64 exec, 1
    ds_add_u32 v26, v12 offset:56
    s_mov_b64 exec, -1
    buffer_load_dwordx4 v[96:99], v21, s[20:23], s60 offen offset:1024
    buffer_load_dwordx4 v[100:103], v21, s[20:23], s60 offen offset:1152
    v_lshlrev_b32 v4, 2, v0
    s_lshl_b32 s60, s47, 3
    s_add_u32 s60, s60, s48
    s_lshl_b32 s60, s60, 7
    s_add_u32 s60, s60, 14090240
    s_mov_b32 exec_hi, 0
    buffer_store_dword v8, v4, s[32:35], s60 offen sc1
    s_lshl_b32 s60, s2, 7
    s_add_u32 s60, s60, 14123008
    buffer_store_dword v8, v4, s[32:35], s60 offen sc1
    s_lshl_b32 s60, s44, 3
    s_add_u32 s60, s60, s45
    s_lshl_b32 s60, s60, 7
    s_lshl_b32 s61, s46, 14
    s_sub_u32 s60, s60, s61
    s_add_u32 s60, s60, 14073856
    buffer_store_dword v8, v4, s[32:35], s60 offen sc1
    s_lshl_b32 s60, s45, 13
    s_lshl_b32 s61, s44, 9
    s_add_u32 s60, s60, s61
    s_lshl_b32 s61, s46, 16
    s_add_u32 s60, s60, s61
    s_add_u32 s60, s60, 12582912
    buffer_store_dwordx4 v[8:11], v23, s[32:35], s60 offen sc1
    s_mov_b64 exec, -1
L_ax_st:
    s_barrier
    s_lshl_b32 s61, s73, 2
    s_mul_i32 s60, s72, 5120
    s_add_u32 s60, s60, 9437184
    s_add_u32 s62, s61, 0
    s_mul_i32 s63, s62, 205
    s_lshr_b32 s63, s63, 10
    s_mul_i32 s65, s63, 5
    s_sub_u32 s62, s62, s65
    s_lshl_b32 s62, s62, 10
    s_mul_i32 s63, s63, 348160
    s_add_u32 s62, s62, s63
    s_add_u32 s62, s62, s60
    buffer_store_dwordx4 v[160:163], v23, s[32:35], s62 offen sc1
    s_add_u32 s62, s61, 1
    s_mul_i32 s63, s62, 205
    s_lshr_b32 s63, s63, 10
    s_mul_i32 s65, s63, 5
    s_sub_u32 s62, s62, s65
    s_lshl_b32 s62, s62, 10
    s_mul_i32 s63, s63, 348160
    s_add_u32 s62, s62, s63
    s_add_u32 s62, s62, s60
    buffer_store_dwordx4 v[164:167], v23, s[32:35], s62 offen sc1
    s_add_u32 s62, s61, 2
    s_mul_i32 s63, s62, 205
    s_lshr_b32 s63, s63, 10
    s_mul_i32 s65, s63, 5
    s_sub_u32 s62, s62, s65
    s_lshl_b32 s62, s62, 10
    s_mul_i32 s63, s63, 348160
    s_add_u32 s62, s62, s63
    s_add_u32 s62, s62, s60
    buffer_store_dwordx4 v[168:171], v23, s[32:35], s62 offen sc1
    s_add_u32 s62, s61, 3
    s_mul_i32 s63, s62, 205
    s_lshr_b32 s63, s63, 10
    s_mul_i32 s65, s63, 5
    s_sub_u32 s62, s62, s65
    s_lshl_b32 s62, s62, 10
    s_mul_i32 s63, s63, 348160
    s_add_u32 s62, s62, s63
    s_add_u32 s62, s62, s60
    buffer_store_dwordx4 v[172:175], v23, s[32:35], s62 offen sc1
    s_cmp_ge_u32 s74, 68
    s_cbranch_scc1 L_pk_2
    s_lshl_b32 s61, s75, 2
    s_mul_i32 s60, s74, 5120
    s_add_u32 s60, s60, 9437184
    s_add_u32 s62, s61, 0
    s_mul_i32 s63, s62, 205
    s_lshr_b32 s63, s63, 10
    s_mul_i32 s65, s63, 5
    s_sub_u32 s62, s62, s65
    s_lshl_b32 s62, s62, 10
    s_mul_i32 s63, s63, 348160
    s_add_u32 s62, s62, s63
    s_add_u32 s62, s62, s60
    buffer_store_dwordx4 v[176:179], v23, s[32:35], s62 offen sc1
    s_add_u32 s62, s61, 1
    s_mul_i32 s63, s62, 205
    s_lshr_b32 s63, s63, 10
    s_mul_i32 s65, s63, 5
    s_sub_u32 s62, s62, s65
    s_lshl_b32 s62, s62, 10
    s_mul_i32 s63, s63, 348160
    s_add_u32 s62, s62, s63
    s_add_u32 s62, s62, s60
    buffer_store_dwordx4 v[180:183], v23, s[32:35], s62 offen sc1
    s_add_u32 s62, s61, 2
    s_mul_i32 s63, s62, 205
    s_lshr_b32 s63, s63, 10
    s_mul_i32 s65, s63, 5
    s_sub_u32 s62, s62, s65
    s_lshl_b32 s62, s62, 10
    s_mul_i32 s63, s63, 348160
    s_add_u32 s62, s62, s63
    s_add_u32 s62, s62, s60
    buffer_store_dwordx4 v[184:187], v23, s[32:35], s62 offen sc1
    s_add_u32 s62, s61, 3
    s_mul_i32 s63, s62, 205
    s_lshr_b32 s63, s63, 10
    s_mul_i32 s65, s63, 5
    s_sub_u32 s62, s62, s65
    s_lshl_b32 s62, s62, 10
    s_mul_i32 s63, s63, 348160
    s_add_u32 s62, s62, s63
    s_add_u32 s62, s62, s60
    buffer_store_dwordx4 v[188:191], v23, s[32:35], s62 offen sc1
L_pk_2:
    v_mov_b64 v[32:33], 0
    v_mov_b64 v[34:35], 0
    v_mov_b64 v[36:37], 0
    v_mov_b64 v[38:39], 0
    s_waitcnt vmcnt(4)
    s_cmp_eq_u32 s50, 3
    s_cbranch_scc1 L_ax_px
    v_lshlrev_b32 v40, 16, v64
    v_and_b32 v41, s64, v64
    v_lshlrev_b32 v42, 16, v65
    v_and_b32 v43, s64, v65
    v_lshlrev_b32 v44, 16, v66
    v_and_b32 v45, s64, v66
    v_lshlrev_b32 v46, 16, v67
    v_and_b32 v47, s64, v67
    v_pk_add_f32 v[32:33], v[32:33], v[40:41]
    v_pk_add_f32 v[34:35], v[34:35], v[42:43]
    v_pk_add_f32 v[36:37], v[36:37], v[44:45]
    v_pk_add_f32 v[38:39], v[38:39], v[46:47]
    v_lshlrev_b32 v40, 16, v68
    v_and_b32 v41, s64, v68
    v_lshlrev_b32 v42, 16, v69
    v_and_b32 v43, s64, v69
    v_lshlrev_b32 v44, 16, v70
    v_and_b32 v45, s64, v70
    v_lshlrev_b32 v46, 16, v71
    v_and_b32 v47, s64, v71
    v_pk_add_f32 v[32:33], v[32:33], v[40:41]
    v_pk_add_f32 v[34:35], v[34:35], v[42:43]
    v_pk_add_f32 v[36:37], v[36:37], v[44:45]
    v_pk_add_f32 v[38:39], v[38:39], v[46:47]
    v_lshlrev_b32 v40, 16, v72
    v_and_b32 v41, s64, v72
    v_lshlrev_b32 v42, 16, v73
    v_and_b32 v43, s64, v73
    v_lshlrev_b32 v44, 16, v74
    v_and_b32 v45, s64, v74
    v_lshlrev_b32 v46, 16, v75
    v_and_b32 v47, s64, v75
    v_pk_add_f32 v[32:33], v[32:33], v[40:41]
    v_pk_add_f32 v[34:35], v[34:35], v[42:43]
    v_pk_add_f32 v[36:37], v[36:37], v[44:45]
    v_pk_add_f32 v[38:39], v[38:39], v[46:47]
    v_lshlrev_b32 v40, 16, v76
    v_and_b32 v41, s64, v76
    v_lshlrev_b32 v42, 16, v77
    v_and_b32 v43, s64, v77
    v_lshlrev_b32 v44, 16, v78
    v_and_b32 v45, s64, v78
    v_lshlrev_b32 v46, 16, v79
    v_and_b32 v47, s64, v79
    v_pk_add_f32 v[32:33], v[32:33], v[40:41]
    v_pk_add_f32 v[34:35], v[34:35], v[42:43]
    v_pk_add_f32 v[36:37], v[36:37], v[44:45]
    v_pk_add_f32 v[38:39], v[38:39], v[46:47]
    v_lshlrev_b32 v40, 16, v80
    v_and_b32 v41, s64, v80
    v_lshlrev_b32 v42, 16, v81
    v_and_b32 v43, s64, v81
    v_lshlrev_b32 v44, 16, v82
    v_and_b32 v45, s64, v82
    v_lshlrev_b32 v46, 16, v83
    v_and_b32 v47, s64, v83
    v_pk_add_f32 v[32:33], v[32:33], v[40:41]
    v_pk_add_f32 v[34:35], v[34:35], v[42:43]
    v_pk_add_f32 v[36:37], v[36:37], v[44:45]
    v_pk_add_f32 v[38:39], v[38:39], v[46:47]
    v_lshlrev_b32 v40, 16, v84
    v_and_b32 v41, s64, v84
    v_lshlrev_b32 v42, 16, v85
    v_and_b32 v43, s64, v85
    v_lshlrev_b32 v44, 16, v86
    v_and_b32 v45, s64, v86
    v_lshlrev_b32 v46, 16, v87
    v_and_b32 v47, s64, v87
    v_pk_add_f32 v[32:33], v[32:33], v[40:41]
    v_pk_add_f32 v[34:35], v[34:35], v[42:43]
    v_pk_add_f32 v[36:37], v[36:37], v[44:45]
    v_pk_add_f32 v[38:39], v[38:39], v[46:47]
    s_barrier
    v_lshlrev_b32 v40, 16, v88
    v_and_b32 v41, s64, v88
    v_lshlrev_b32 v42, 16, v89
    v_and_b32 v43, s64, v89
    v_lshlrev_b32 v44, 16, v90
    v_and_b32 v45, s64, v90
    v_lshlrev_b32 v46, 16, v91
    v_and_b32 v47, s64, v91
    v_pk_add_f32 v[32:33], v[32:33], v[40:41]
    v_pk_add_f32 v[34:35], v[34:35], v[42:43]
    v_pk_add_f32 v[36:37], v[36:37], v[44:45]
    v_pk_add_f32 v[38:39], v[38:39], v[46:47]
    v_lshlrev_b32 v40, 16, v92
    v_and_b32 v41, s64, v92
    v_lshlrev_b32 v42, 16, v93
    v_and_b32 v43, s64, v93
    v_lshlrev_b32 v44, 16, v94
    v_and_b32 v45, s64, v94
    v_lshlrev_b32 v46, 16, v95
    v_and_b32 v47, s64, v95
    v_pk_add_f32 v[32:33], v[32:33], v[40:41]
    v_pk_add_f32 v[34:35], v[34:35], v[42:43]
    v_pk_add_f32 v[36:37], v[36:37], v[44:45]
    v_pk_add_f32 v[38:39], v[38:39], v[46:47]
    v_lshlrev_b32 v40, 16, v96
    v_and_b32 v41, s64, v96
    v_lshlrev_b32 v42, 16, v97
    v_and_b32 v43, s64, v97
    v_lshlrev_b32 v44, 16, v98
    v_and_b32 v45, s64, v98
    v_lshlrev_b32 v46, 16, v99
    v_and_b32 v47, s64, v99
    v_pk_add_f32 v[32:33], v[32:33], v[40:41]
    v_pk_add_f32 v[34:35], v[34:35], v[42:43]
    v_pk_add_f32 v[36:37], v[36:37], v[44:45]
    v_pk_add_f32 v[38:39], v[38:39], v[46:47]
    v_lshlrev_b32 v40, 16, v100
    v_and_b32 v41, s64, v100
    v_lshlrev_b32 v42, 16, v101
    v_and_b32 v43, s64, v101
    v_lshlrev_b32 v44, 16, v102
    v_and_b32 v45, s64, v102
    v_lshlrev_b32 v46, 16, v103
    v_and_b32 v47, s64, v103
    v_pk_add_f32 v[32:33], v[32:33], v[40:41]
    v_pk_add_f32 v[34:35], v[34:35], v[42:43]
    v_pk_add_f32 v[36:37], v[36:37], v[44:45]
    v_pk_add_f32 v[38:39], v[38:39], v[46:47]
    v_lshlrev_b32 v40, 16, v104
    v_and_b32 v41, s64, v104
    v_lshlrev_b32 v42, 16, v105
    v_and_b32 v43, s64, v105
    v_lshlrev_b32 v44, 16, v106
    v_and_b32 v45, s64, v106
    v_lshlrev_b32 v46, 16, v107
    v_and_b32 v47, s64, v107
    v_pk_add_f32 v[32:33], v[32:33], v[40:41]
    v_pk_add_f32 v[34:35], v[34:35], v[42:43]
    v_pk_add_f32 v[36:37], v[36:37], v[44:45]
    v_pk_add_f32 v[38:39], v[38:39], v[46:47]
    v_lshlrev_b32 v40, 16, v108
    v_and_b32 v41, s64, v108
    v_lshlrev_b32 v42, 16, v109
    v_and_b32 v43, s64, v109
    v_lshlrev_b32 v44, 16, v110
    v_and_b32 v45, s64, v110
    v_lshlrev_b32 v46, 16, v111
    v_and_b32 v47, s64, v111
    v_pk_add_f32 v[32:33], v[32:33], v[40:41]
    v_pk_add_f32 v[34:35], v[34:35], v[42:43]
    v_pk_add_f32 v[36:37], v[36:37], v[44:45]
    v_pk_add_f32 v[38:39], v[38:39], v[46:47]
    v_lshlrev_b32 v40, 16, v112
    v_and_b32 v41, s64, v112
    v_lshlrev_b32 v42, 16, v113
    v_and_b32 v43, s64, v113
    v_lshlrev_b32 v44, 16, v114
    v_and_b32 v45, s64, v114
    v_lshlrev_b32 v46, 16, v115
    v_and_b32 v47, s64, v115
    v_pk_add_f32 v[32:33], v[32:33], v[40:41]
    v_pk_add_f32 v[34:35], v[34:35], v[42:43]
    v_pk_add_f32 v[36:37], v[36:37], v[44:45]
    v_pk_add_f32 v[38:39], v[38:39], v[46:47]
    v_lshlrev_b32 v40, 16, v116
    v_and_b32 v41, s64, v116
    v_lshlrev_b32 v42, 16, v117
    v_and_b32 v43, s64, v117
    v_lshlrev_b32 v44, 16, v118
    v_and_b32 v45, s64, v118
    v_lshlrev_b32 v46, 16, v119
    v_and_b32 v47, s64, v119
    v_pk_add_f32 v[32:33], v[32:33], v[40:41]
    v_pk_add_f32 v[34:35], v[34:35], v[42:43]
    v_pk_add_f32 v[36:37], v[36:37], v[44:45]
    v_pk_add_f32 v[38:39], v[38:39], v[46:47]
    v_lshlrev_b32 v40, 16, v120
    v_and_b32 v41, s64, v120
    v_lshlrev_b32 v42, 16, v121
    v_and_b32 v43, s64, v121
    v_lshlrev_b32 v44, 16, v122
    v_and_b32 v45, s64, v122
    v_lshlrev_b32 v46, 16, v123
    v_and_b32 v47, s64, v123
    v_pk_add_f32 v[32:33], v[32:33], v[40:41]
    v_pk_add_f32 v[34:35], v[34:35], v[42:43]
    v_pk_add_f32 v[36:37], v[36:37], v[44:45]
    v_pk_add_f32 v[38:39], v[38:39], v[46:47]
    v_lshlrev_b32 v40, 16, v124
    v_and_b32 v41, s64, v124
    v_lshlrev_b32 v42, 16, v125
    v_and_b32 v43, s64, v125
    v_lshlrev_b32 v44, 16, v126
    v_and_b32 v45, s64, v126
    v_lshlrev_b32 v46, 16, v127
    v_and_b32 v47, s64, v127
    v_pk_add_f32 v[32:33], v[32:33], v[40:41]
    v_pk_add_f32 v[34:35], v[34:35], v[42:43]
    v_pk_add_f32 v[36:37], v[36:37], v[44:45]
    v_pk_add_f32 v[38:39], v[38:39], v[46:47]
    v_lshlrev_b32 v40, 16, v128
    v_and_b32 v41, s64, v128
    v_lshlrev_b32 v42, 16, v129
    v_and_b32 v43, s64, v129
    v_lshlrev_b32 v44, 16, v130
    v_and_b32 v45, s64, v130
    v_lshlrev_b32 v46, 16, v131
    v_and_b32 v47, s64, v131
    v_pk_add_f32 v[32:33], v[32:33], v[40:41]
    v_pk_add_f32 v[34:35], v[34:35], v[42:43]
    v_pk_add_f32 v[36:37], v[36:37], v[44:45]
    v_pk_add_f32 v[38:39], v[38:39], v[46:47]
    v_lshlrev_b32 v40, 16, v132
    v_and_b32 v41, s64, v132
    v_lshlrev_b32 v42, 16, v133
    v_and_b32 v43, s64, v133
    v_lshlrev_b32 v44, 16, v134
    v_and_b32 v45, s64, v134
    v_lshlrev_b32 v46, 16, v135
    v_and_b32 v47, s64, v135
    v_pk_add_f32 v[32:33], v[32:33], v[40:41]
    v_pk_add_f32 v[34:35], v[34:35], v[42:43]
    v_pk_add_f32 v[36:37], v[36:37], v[44:45]
    v_pk_add_f32 v[38:39], v[38:39], v[46:47]
    s_barrier
    v_lshlrev_b32 v40, 16, v136
    v_and_b32 v41, s64, v136
    v_lshlrev_b32 v42, 16, v137
    v_and_b32 v43, s64, v137
    v_lshlrev_b32 v44, 16, v138
    v_and_b32 v45, s64, v138
    v_lshlrev_b32 v46, 16, v139
    v_and_b32 v47, s64, v139
    v_pk_add_f32 v[32:33], v[32:33], v[40:41]
    v_pk_add_f32 v[34:35], v[34:35], v[42:43]
    v_pk_add_f32 v[36:37], v[36:37], v[44:45]
    v_pk_add_f32 v[38:39], v[38:39], v[46:47]
    v_lshlrev_b32 v40, 16, v140
    v_and_b32 v41, s64, v140
    v_lshlrev_b32 v42, 16, v141
    v_and_b32 v43, s64, v141
    v_lshlrev_b32 v44, 16, v142
    v_and_b32 v45, s64, v142
    v_lshlrev_b32 v46, 16, v143
    v_and_b32 v47, s64, v143
    v_pk_add_f32 v[32:33], v[32:33], v[40:41]
    v_pk_add_f32 v[34:35], v[34:35], v[42:43]
    v_pk_add_f32 v[36:37], v[36:37], v[44:45]
    v_pk_add_f32 v[38:39], v[38:39], v[46:47]
    s_nop 0
    v_permlane32_swap_b32 v32, v36
    v_permlane32_swap_b32 v33, v37
    v_permlane32_swap_b32 v34, v38
    v_permlane32_swap_b32 v35, v39
    v_add_f32 v32, v32, v36
    v_add_f32 v33, v33, v37
    v_add_f32 v34, v34, v38
    v_add_f32 v35, v35, v39
    s_nop 0
    v_permlane16_swap_b32 v32, v34
    v_permlane16_swap_b32 v33, v35
    v_add_f32 v32, v32, v34
    v_add_f32 v33, v33, v35
    s_nop 0
    v_add_f32_dpp v32, v32, v32 row_ror:8 row_mask:0xf bank_mask:0xf
    v_add_f32_dpp v33, v33, v33 row_ror:8 row_mask:0xf bank_mask:0xf
    v_lshlrev_b32 v4, 3, v3
    v_lshl_add_u32 v4, v2, 5, v4
    s_lshl_b32 s62, s69, 14
    s_lshl_b32 s61, s59, 8
    s_add_u32 s61, s61, s62
    s_add_u32 s61, s61, 13631488
    buffer_store_dwordx2 v[32:33], v4, s[32:35], s61 offen sc1
    s_branch L_ax_done
L_ax_px:
    v_lshlrev_b32 v40, 16, v64
    v_and_b32 v41, s64, v64
    v_lshlrev_b32 v42, 16, v65
    v_and_b32 v43, s64, v65
    v_lshlrev_b32 v44, 16, v66
    v_and_b32 v45, s64, v66
    v_lshlrev_b32 v46, 16, v67
    v_and_b32 v47, s64, v67
    v_pk_add_f32 v[32:33], v[32:33], v[40:41]
    v_pk_fma_f32 v[34:35], v[40:41], v[40:41], v[34:35]
    v_pk_add_f32 v[36:37], v[36:37], v[42:43]
    v_pk_fma_f32 v[38:39], v[42:43], v[42:43], v[38:39]
    v_pk_add_f32 v[32:33], v[32:33], v[44:45]
    v_pk_fma_f32 v[34:35], v[44:45], v[44:45], v[34:35]
    v_pk_add_f32 v[36:37], v[36:37], v[46:47]
    v_pk_fma_f32 v[38:39], v[46:47], v[46:47], v[38:39]
    v_lshlrev_b32 v40, 16, v68
    v_and_b32 v41, s64, v68
    v_lshlrev_b32 v42, 16, v69
    v_and_b32 v43, s64, v69
    v_lshlrev_b32 v44, 16, v70
    v_and_b32 v45, s64, v70
    v_lshlrev_b32 v46, 16, v71
    v_and_b32 v47, s64, v71
    v_pk_add_f32 v[32:33], v[32:33], v[40:41]
    v_pk_fma_f32 v[34:35], v[40:41], v[40:41], v[34:35]
    v_pk_add_f32 v[36:37], v[36:37], v[42:43]
    v_pk_fma_f32 v[38:39], v[42:43], v[42:43], v[38:39]
    v_pk_add_f32 v[32:33], v[32:33], v[44:45]
    v_pk_fma_f32 v[34:35], v[44:45], v[44:45], v[34:35]
    v_pk_add_f32 v[36:37], v[36:37], v[46:47]
    v_pk_fma_f32 v[38:39], v[46:47], v[46:47], v[38:39]
    v_lshlrev_b32 v40, 16, v72
    v_and_b32 v41, s64, v72
    v_lshlrev_b32 v42, 16, v73
    v_and_b32 v43, s64, v73
    v_lshlrev_b32 v44, 16, v74
    v_and_b32 v45, s64, v74
    v_lshlrev_b32 v46, 16, v75
    v_and_b32 v47, s64, v75
    v_pk_add_f32 v[32:33], v[32:33], v[40:41]
    v_pk_fma_f32 v[34:35], v[40:41], v[40:41], v[34:35]
    v_pk_add_f32 v[36:37], v[36:37], v[42:43]
    v_pk_fma_f32 v[38:39], v[42:43], v[42:43], v[38:39]
    v_pk_add_f32 v[32:33], v[32:33], v[44:45]
    v_pk_fma_f32 v[34:35], v[44:45], v[44:45], v[34:35]
    v_pk_add_f32 v[36:37], v[36:37], v[46:47]
    v_pk_fma_f32 v[38:39], v[46:47], v[46:47], v[38:39]
    v_lshlrev_b32 v40, 16, v76
    v_and_b32 v41, s64, v76
    v_lshlrev_b32 v42, 16, v77
    v_and_b32 v43, s64, v77
    v_lshlrev_b32 v44, 16, v78
    v_and_b32 v45, s64, v78
    v_lshlrev_b32 v46, 16, v79
    v_and_b32 v47, s64, v79
    v_pk_add_f32 v[32:33], v[32:33], v[40:41]
    v_pk_fma_f32 v[34:35], v[40:41], v[40:41], v[34:35]
    v_pk_add_f32 v[36:37], v[36:37], v[42:43]
    v_pk_fma_f32 v[38:39], v[42:43], v[42:43], v[38:39]
    v_pk_add_f32 v[32:33], v[32:33], v[44:45]
    v_pk_fma_f32 v[34:35], v[44:45], v[44:45], v[34:35]
    v_pk_add_f32 v[36:37], v[36:37], v[46:47]
    v_pk_fma_f32 v[38:39], v[46:47], v[46:47], v[38:39]
    s_barrier
    v_lshlrev_b32 v40, 16, v80
    v_and_b32 v41, s64, v80
    v_lshlrev_b32 v42, 16, v81
    v_and_b32 v43, s64, v81
    v_lshlrev_b32 v44, 16, v82
    v_and_b32 v45, s64, v82
    v_lshlrev_b32 v46, 16, v83
    v_and_b32 v47, s64, v83
    v_pk_add_f32 v[32:33], v[32:33], v[40:41]
    v_pk_fma_f32 v[34:35], v[40:41], v[40:41], v[34:35]
    v_pk_add_f32 v[36:37], v[36:37], v[42:43]
    v_pk_fma_f32 v[38:39], v[42:43], v[42:43], v[38:39]
    v_pk_add_f32 v[32:33], v[32:33], v[44:45]
    v_pk_fma_f32 v[34:35], v[44:45], v[44:45], v[34:35]
    v_pk_add_f32 v[36:37], v[36:37], v[46:47]
    v_pk_fma_f32 v[38:39], v[46:47], v[46:47], v[38:39]
    v_lshlrev_b32 v40, 16, v84
    v_and_b32 v41, s64, v84
    v_lshlrev_b32 v42, 16, v85
    v_and_b32 v43, s64, v85
    v_lshlrev_b32 v44, 16, v86
    v_and_b32 v45, s64, v86
    v_lshlrev_b32 v46, 16, v87
    v_and_b32 v47, s64, v87
    v_pk_add_f32 v[32:33], v[32:33], v[40:41]
    v_pk_fma_f32 v[34:35], v[40:41], v[40:41], v[34:35]
    v_pk_add_f32 v[36:37], v[36:37], v[42:43]
    v_pk_fma_f32 v[38:39], v[42:43], v[42:43], v[38:39]
    v_pk_add_f32 v[32:33], v[32:33], v[44:45]
    v_pk_fma_f32 v[34:35], v[44:45], v[44:45], v[34:35]
    v_pk_add_f32 v[36:37], v[36:37], v[46:47]
    v_pk_fma_f32 v[38:39], v[46:47], v[46:47], v[38:39]
    v_lshlrev_b32 v40, 16, v88
    v_and_b32 v41, s64, v88
    v_lshlrev_b32 v42, 16, v89
    v_and_b32 v43, s64, v89
    v_lshlrev_b32 v44, 16, v90
    v_and_b32 v45, s64, v90
    v_lshlrev_b32 v46, 16, v91
    v_and_b32 v47, s64, v91
    v_pk_add_f32 v[32:33], v[32:33], v[40:41]
    v_pk_fma_f32 v[34:35], v[40:41], v[40:41], v[34:35]
    v_pk_add_f32 v[36:37], v[36:37], v[42:43]
    v_pk_fma_f32 v[38:39], v[42:43], v[42:43], v[38:39]
    v_pk_add_f32 v[32:33], v[32:33], v[44:45]
    v_pk_fma_f32 v[34:35], v[44:45], v[44:45], v[34:35]
    v_pk_add_f32 v[36:37], v[36:37], v[46:47]
    v_pk_fma_f32 v[38:39], v[46:47], v[46:47], v[38:39]
    v_lshlrev_b32 v40, 16, v92
    v_and_b32 v41, s64, v92
    v_lshlrev_b32 v42, 16, v93
    v_and_b32 v43, s64, v93
    v_lshlrev_b32 v44, 16, v94
    v_and_b32 v45, s64, v94
    v_lshlrev_b32 v46, 16, v95
    v_and_b32 v47, s64, v95
    v_pk_add_f32 v[32:33], v[32:33], v[40:41]
    v_pk_fma_f32 v[34:35], v[40:41], v[40:41], v[34:35]
    v_pk_add_f32 v[36:37], v[36:37], v[42:43]
    v_pk_fma_f32 v[38:39], v[42:43], v[42:43], v[38:39]
    v_pk_add_f32 v[32:33], v[32:33], v[44:45]
    v_pk_fma_f32 v[34:35], v[44:45], v[44:45], v[34:35]
    v_pk_add_f32 v[36:37], v[36:37], v[46:47]
    v_pk_fma_f32 v[38:39], v[46:47], v[46:47], v[38:39]
    v_lshlrev_b32 v40, 16, v96
    v_and_b32 v41, s64, v96
    v_lshlrev_b32 v42, 16, v97
    v_and_b32 v43, s64, v97
    v_lshlrev_b32 v44, 16, v98
    v_and_b32 v45, s64, v98
    v_lshlrev_b32 v46, 16, v99
    v_and_b32 v47, s64, v99
    v_pk_add_f32 v[32:33], v[32:33], v[40:41]
    v_pk_fma_f32 v[34:35], v[40:41], v[40:41], v[34:35]
    v_pk_add_f32 v[36:37], v[36:37], v[42:43]
    v_pk_fma_f32 v[38:39], v[42:43], v[42:43], v[38:39]
    v_pk_add_f32 v[32:33], v[32:33], v[44:45]
    v_pk_fma_f32 v[34:35], v[44:45], v[44:45], v[34:35]
    v_pk_add_f32 v[36:37], v[36:37], v[46:47]
    v_pk_fma_f32 v[38:39], v[46:47], v[46:47], v[38:39]
    v_lshlrev_b32 v40, 16, v100
    v_and_b32 v41, s64, v100
    v_lshlrev_b32 v42, 16, v101
    v_and_b32 v43, s64, v101
    v_lshlrev_b32 v44, 16, v102
    v_and_b32 v45, s64, v102
    v_lshlrev_b32 v46, 16, v103
    v_and_b32 v47, s64, v103
    v_pk_add_f32 v[32:33], v[32:33], v[40:41]
    v_pk_fma_f32 v[34:35], v[40:41], v[40:41], v[34:35]
    v_pk_add_f32 v[36:37], v[36:37], v[42:43]
    v_pk_fma_f32 v[38:39], v[42:43], v[42:43], v[38:39]
    v_pk_add_f32 v[32:33], v[32:33], v[44:45]
    v_pk_fma_f32 v[34:35], v[44:45], v[44:45], v[34:35]
    v_pk_add_f32 v[36:37], v[36:37], v[46:47]
    v_pk_fma_f32 v[38:39], v[46:47], v[46:47], v[38:39]
    s_barrier
    v_pk_add_f32 v[32:33], v[32:33], v[36:37]
    v_pk_add_f32 v[34:35], v[34:35], v[38:39]
    v_add_f32 v33, v32, v33
    v_add_f32 v32, v34, v35
    s_nop 1
    v_add_f32_dpp v32, v32, v32 quad_perm:[1,0,3,2] row_mask:0xf bank_mask:0xf
    v_add_f32_dpp v33, v33, v33 quad_perm:[1,0,3,2] row_mask:0xf bank_mask:0xf
    s_nop 0
    v_add_f32_dpp v32, v32, v32 quad_perm:[2,3,0,1] row_mask:0xf bank_mask:0xf
    v_add_f32_dpp v33, v33, v33 quad_perm:[2,3,0,1] row_mask:0xf bank_mask:0xf
    s_nop 0
    v_add_f32_dpp v32, v32, v32 row_half_mirror row_mask:0xf bank_mask:0xf
    v_add_f32_dpp v33, v33, v33 row_half_mirror row_mask:0xf bank_mask:0xf
    v_mul_f32 v33, 0x3acccccd, v33
    v_mul_f32 v32, 0x3acccccd, v32
    v_fma_f32 v32, -v33, v33, v32
    v_max_f32 v32, 0, v32
    v_add_f32 v32, 0x3727c5ac, v32
    v_rsq_f32 v32, v32
    v_lshlrev_b32 v4, 3, v1
    s_lshl_b32 s60, s69, 6
    s_add_u32 s60, s60, 13893632
    buffer_store_dwordx2 v[32:33], v4, s[32:35], s60 offen sc1
L_ax_done:
    s_waitcnt vmcnt(0)
    v_mov_b32 v8, 1
    s_mov_b64 exec, 1
    ds_add_rtn_u32 v9, v26, v8 offset:28
    s_mov_b64 exec, -1
    s_waitcnt lgkmcnt(0)
    v_readfirstlane_b32 s60, v9
    s_nop 0
    s_mov_b32 s58, s60
    s_cmp_eq_u32 s58, 1
    s_cbranch_scc0 L_ax_n1
    s_and_b32 s60, s2, 7
    s_lshl_b32 s60, s60, 5
    v_mov_b32 v4, s60
    v_mov_b32 v31, 1
    s_mov_b64 exec, 1
    buffer_atomic_add v31, v4, s[40:43], 0 offen sc0 sc1
    s_mov_b64 exec, -1
L_ax_n1:
    s_barrier
    s_cmp_eq_u32 s58, 1
    s_cbranch_scc0 L_ax_n2
    s_waitcnt vmcnt(0)
    v_readfirstlane_b32 s58, v31
    s_nop 0
    s_and_b32 s58, s58, 31
    s_cmp_eq_u32 s58, 31
    s_cbranch_scc0 L_ax_n2
    v_mov_b32 v4, 16
    v_mov_b32 v31, 1
    s_mov_b64 exec, 1
    buffer_atomic_add v31, v4, s[40:43], 0 offen sc0 sc1
    s_mov_b64 exec, -1
    s_waitcnt vmcnt(0)
    v_readfirstlane_b32 s60, v31
    s_nop 0
    s_and_b32 s60, s60, 7
    s_cmp_eq_u32 s60, 7
    s_cbranch_scc0 L_ax_n2
    v_lshlrev_b32 v4, 7, v0
    v_mov_b32 v5, 1
    s_mov_b32 s60, 14123008
    buffer_store_dword v5, v4, s[32:35], s60 offen sc1
    s_add_u32 s60, s60, 8192
    buffer_store_dword v5, v4, s[32:35], s60 offen sc1
    s_add_u32 s60, s60, 8192
    buffer_store_dword v5, v4, s[32:35], s60 offen sc1
    s_add_u32 s60, s60, 8192
    buffer_store_dword v5, v4, s[32:35], s60 offen sc1
L_ax_n2:
    s_lshl_b32 s60, s50, 6
    s_sub_u32 s60, s60, 128
    v_add_u32 v20, s60, v0
    v_mov_b32 v29, 0
    s_lshl_b32 s58, s2, 7
    s_add_u32 s58, s58, 14123008
    s_mul_i32 s60, s45, 320
    s_mul_i32 s61, s45, 768
    s_add_u32 s63, s60, 2560
    s_add_u32 s64, s60, 4800
    s_add_u32 s61, s61, 7680
    s_sub_u32 s60, s60, 768
    s_cmp_eq_u32 s46, 0
    s_cselect_b32 s63, s63, s61
    s_cselect_b32 s64, s64, s60
    s_cselect_b32 s65, 20, 48
    v_mov_b32 v2, s63
    v_mov_b32 v3, s64
    v_cmp_gt_u32 vcc, s65, v20
    s_nop 1
    v_cndmask_b32 v2, v3, v2, vcc
    v_lshl_add_u32 v1, v20, 4, v2
    v_lshlrev_b32 v2, 3, v20
    s_barrier
    s_barrier
    s_cmp_eq_u32 s46, 0
    s_cbranch_scc0 L_ax_chk
    s_barrier
L_ax_chk:
    buffer_load_dword v30, v29, s[32:35], s58 offen sc1
    s_mov_b32 s62, 0
    s_barrier
    s_waitcnt vmcnt(0)
L_arr:
    v_readfirstlane_b32 s60, v30
    s_nop 0
    s_cmp_eq_u32 s60, 1
    s_cbranch_scc1 L_arr_ok
    s_sleep 2
    buffer_load_dword v30, v29, s[32:35], s58 offen sc1
    s_add_u32 s62, s62, 1
    s_cmp_lt_u32 s62, 0x80000
    s_waitcnt vmcnt(0)
    s_cbranch_scc1 L_arr
L_arr_ok:
    s_mov_b32 s61, 13631488
    buffer_load_dwordx4 v[32:35], v1, s[32:35], s61 offen sc1
    s_add_u32 s61, s61, 16384
    buffer_load_dwordx4 v[36:39], v1, s[32:35], s61 offen sc1
    s_add_u32 s61, s61, 16384
    buffer_load_dwordx4 v[40:43], v1, s[32:35], s61 offen sc1
    s_add_u32 s61, s61, 16384
    buffer_load_dwordx4 v[44:47], v1, s[32:35], s61 offen sc1
    s_lshl_b32 s61, s44, 10
    s_add_u32 s61, s61, 13893632
    buffer_load_dwordx2 v[72:73], v2, s[32:35], s61 offen sc1
    v_lshlrev_b32 v3, 1, v2
    v_add_u32 v3, 159744, v3
    v_add_u32 v5, 160896, v2
    v_lshrrev_b32 v4, 1, v2
    v_add_u32 v4, 161920, v4
    v_cmp_gt_u32 vcc, 68, v20
    s_barrier
    s_waitcnt vmcnt(0)
    v_pk_add_f32 v[32:33], v[32:33], v[36:37]
    v_pk_add_f32 v[34:35], v[34:35], v[38:39]
    v_pk_add_f32 v[32:33], v[32:33], v[40:41]
    v_pk_add_f32 v[34:35], v[34:35], v[42:43]
    v_pk_add_f32 v[32:33], v[32:33], v[44:45]
    v_pk_add_f32 v[34:35], v[34:35], v[46:47]
    ds_write_b64 v5, v[72:73]
    ds_write_b32 v4, v72
    ds_write_b32 v4, v73 offset:512
    s_mov_b64 exec, vcc
    ds_write_b128 v3, v[32:35]
    s_mov_b64 exec, -1
    s_waitcnt lgkmcnt(0)
    s_cmp_eq_u32 s46, 0
    s_cbranch_scc1 L_phase2b
L_phase2:
    s_cmp_eq_u32 s46, 0
    s_cbranch_scc1 L_p2A
    s_mul_i32 s64, s47, 68
    s_add_u32 s64, s64, s50
    s_lshl_b32 s64, s64, 12
    s_mul_i32 s65, s48, 68
    s_add_u32 s65, s65, s50
    s_mul_i32 s65, s65, 5120
    s_add_u32 s65, s65, 9437184
    s_mul_i32 s67, s50, 39936
    v_lshlrev_b32 v1, 4, v0
    v_add_u32 v2, 4096, v1
    s_add_u32 s61, s65, 245760
    s_add_u32 m0, s67, 16384
    s_nop 0
    buffer_load_dwordx4 v1, s[32:35], s61 offen offset:0 sc1 lds
    s_add_u32 m0, s67, 16384
    s_nop 0
    buffer_load_dwordx4 v1, s[32:35], s61 offen offset:1024 sc1 lds
    s_add_u32 m0, s67, 16384
    s_nop 0
    buffer_load_dwordx4 v1, s[32:35], s61 offen offset:2048 sc1 lds
    s_add_u32 m0, s67, 16384
    s_nop 0
    buffer_load_dwordx4 v1, s[32:35], s61 offen offset:3072 sc1 lds
    s_add_u32 m0, s67, 20480
    s_nop 0
    buffer_load_dwordx4 v2, s[32:35], s61 offen sc1 lds
    s_add_u32 s61, s65, 266240
    s_add_u32 m0, s67, 21504
    s_nop 0
    buffer_load_dwordx4 v1, s[32:35], s61 offen offset:0 sc1 lds
    s_add_u32 m0, s67, 21504
    s_nop 0
    buffer_load_dwordx4 v1, s[32:35], s61 offen offset:1024 sc1 lds
    s_add_u32 m0, s67, 21504
    s_nop 0
    buffer_load_dwordx4 v1, s[32:35], s61 offen offset:2048 sc1 lds
    s_add_u32 m0, s67, 21504
    s_nop 0
    buffer_load_dwordx4 v1, s[32:35], s61 offen offset:3072 sc1 lds
    s_add_u32 m0, s67, 25600
    s_nop 0
    buffer_load_dwordx4 v2, s[32:35], s61 offen sc1 lds
    s_add_u32 s61, s65, 0
    buffer_load_dwordx4 v[104:107], v1, s[32:35], s61 offen offset:0 sc1
    buffer_load_dwordx4 v[108:111], v1, s[32:35], s61 offen offset:1024 sc1
    buffer_load_dwordx4 v[112:115], v1, s[32:35], s61 offen offset:2048 sc1
    buffer_load_dwordx4 v[116:119], v1, s[32:35], s61 offen offset:3072 sc1
    buffer_load_dwordx4 v[120:123], v2, s[32:35], s61 offen sc1
    s_barrier
    s_add_u32 s61, s65, 286720
    s_add_u32 m0, s67, 26624
    s_nop 0
    buffer_load_dwordx4 v1, s[32:35], s61 offen offset:0 sc1 lds
    s_add_u32 m0, s67, 26624
    s_nop 0
    buffer_load_dwordx4 v1, s[32:35], s61 offen offset:1024 sc1 lds
    s_add_u32 m0, s67, 26624
    s_nop 0
    buffer_load_dwordx4 v1, s[32:35], s61 offen offset:2048 sc1 lds
    s_add_u32 m0, s67, 26624
    s_nop 0
    buffer_load_dwordx4 v1, s[32:35], s61 offen offset:3072 sc1 lds
    s_add_u32 m0, s67, 30720
    s_nop 0
    buffer_load_dwordx4 v2, s[32:35], s61 offen sc1 lds
    s_add_u32 s61, s65, 307200
    s_add_u32 m0, s67, 31744
    s_nop 0
    buffer_load_dwordx4 v1, s[32:35], s61 offen offset:0 sc1 lds
    s_add_u32 m0, s67, 31744
    s_nop 0
    buffer_load_dwordx4 v1, s[32:35], s61 offen offset:1024 sc1 lds
    s_add_u32 m0, s67, 31744
    s_nop 0
    buffer_load_dwordx4 v1, s[32:35], s61 offen offset:2048 sc1 lds
    s_add_u32 m0, s67, 31744
    s_nop 0
    buffer_load_dwordx4 v1, s[32:35], s61 offen offset:3072 sc1 lds
    s_add_u32 m0, s67, 35840
    s_nop 0
    buffer_load_dwordx4 v2, s[32:35], s61 offen sc1 lds
    s_add_u32 s61, s65, 20480
    buffer_load_dwordx4 v[124:127], v1, s[32:35], s61 offen offset:0 sc1
    buffer_load_dwordx4 v[128:131], v1, s[32:35], s61 offen offset:1024 sc1
    buffer_load_dwordx4 v[132:135], v1, s[32:35], s61 offen offset:2048 sc1
    buffer_load_dwordx4 v[136:139], v1, s[32:35], s61 offen offset:3072 sc1
    buffer_load_dwordx4 v[140:143], v2, s[32:35], s61 offen sc1
    s_add_u32 s61, s65, 40960
    buffer_load_dwordx4 v[144:147], v1, s[32:35], s61 offen offset:0 sc1
    buffer_load_dwordx4 v[148:151], v1, s[32:35], s61 offen offset:1024 sc1
    buffer_load_dwordx4 v[152:155], v1, s[32:35], s61 offen offset:2048 sc1
    buffer_load_dwordx4 v[156:159], v1, s[32:35], s61 offen offset:3072 sc1
    buffer_load_dwordx4 v[160:163], v2, s[32:35], s61 offen sc1
    s_branch L_p2c
L_p2A:
    s_barrier
L_phase2b:
    s_mul_i32 s64, s47, 68
    s_add_u32 s64, s64, s50
    s_lshl_b32 s64, s64, 12
    s_mul_i32 s65, s48, 68
    s_add_u32 s65, s65, s50
    s_mul_i32 s65, s65, 5120
    s_add_u32 s65, s65, 9437184
    s_mul_i32 s67, s50, 39936
    v_lshlrev_b32 v1, 4, v0
    v_add_u32 v2, 4096, v1
L_p2c:
    s_setprio 0
    s_mov_b32 s36, s18
    s_and_b32 s37, s19, 0xffff
    s_mov_b32 s38, 2621440
    s_mov_b32 s39, 0x20000
    s_lshl_b32 s60, s47, 2
    s_add_u32 s60, s60, s50
    s_mul_i32 s66, s60, 20480
    s_lshl_b32 s68, s60, 7
    s_add_u32 s68, s68, 13893632
    s_mul_i32 s61, s48, 160
    s_add_u32 s66, s66, s61
    v_add_u32 v27, s67, v1
    v_mov_b32 v26, 162944
    s_lshl_b32 s59, s47, 3
    s_add_u32 s59, s59, s48
    s_lshl_b32 s59, s59, 7
    s_add_u32 s59, s59, 14090240
    s_mul_i32 s69, s50, 5376
    s_add_u32 s69, s69, 16384
    v_add_u32 v4, 0, v0
    v_mul_u32_u24 v5, 205, v4
    v_lshrrev_b32 v5, 11, v5
    v_mul_u32_u24 v6, 10, v5
    v_sub_u32 v6, v4, v6
    v_mul_u32_u24 v7, 336, v5
    v_lshl_add_u32 v7, v6, 5, v7
    v_add_u32 v10, s69, v7
    v_mul_u32_u24 v7, 1280, v5
    v_lshl_add_u32 v13, v6, 4, v7
    v_lshlrev_b32 v16, 3, v5
    v_add_u32 v4, 64, v0
    v_mul_u32_u24 v5, 205, v4
    v_lshrrev_b32 v5, 11, v5
    v_mul_u32_u24 v6, 10, v5
    v_sub_u32 v6, v4, v6
    v_mul_u32_u24 v7, 336, v5
    v_lshl_add_u32 v7, v6, 5, v7
    v_add_u32 v11, s69, v7
    v_mul_u32_u24 v7, 1280, v5
    v_lshl_add_u32 v14, v6, 4, v7
    v_lshlrev_b32 v17, 3, v5
    v_add_u32 v4, 128, v0
    v_mul_u32_u24 v5, 205, v4
    v_lshrrev_b32 v5, 11, v5
    v_mul_u32_u24 v6, 10, v5
    v_sub_u32 v6, v4, v6
    v_mul_u32_u24 v7, 336, v5
    v_lshl_add_u32 v7, v6, 5, v7
    v_add_u32 v12, s69, v7
    v_mul_u32_u24 v7, 1280, v5
    v_lshl_add_u32 v15, v6, 4, v7
    v_lshlrev_b32 v18, 3, v5
    v_mov_b32 v4, 0x7fffffff
    v_cmp_gt_u32 vcc, 32, v0
    s_nop 1
    v_cndmask_b32 v15, v4, v15, vcc
    v_cndmask_b32 v12, v10, v12, vcc
    v_and_b32 v4, 15, v0
    v_lshlrev_b32 v28, 2, v4
    v_mul_u32_u24 v4, 336, v4
    v_lshrrev_b32 v5, 4, v0
    v_lshl_add_u32 v4, v5, 4, v4
    s_add_u32 s60, s67, 16384
    v_add_u32 v25, s60, v4
    s_barrier
    s_cmp_eq_u32 s46, 0
    s_cbranch_scc1 L_nozf
    v_mov_b64 v[4:5], 0
    v_mov_b64 v[6:7], 0
    ds_write_b128 v27, v[4:7] offset:5120
    ds_write_b128 v27, v[4:7] offset:6144
    ds_write_b128 v27, v[4:7] offset:7168
    ds_write_b128 v27, v[4:7] offset:8192
    ds_write_b128 v27, v[4:7] offset:9216
    s_waitcnt lgkmcnt(0)
    v_mov_b32 v8, 1
    s_mov_b64 exec, 1
    ds_add_u32 v26, v8 offset:32
    s_mov_b64 exec, -1
    s_mov_b32 s62, 0
L_sp_hs:
    ds_read_b32 v3, v26 offset:0
    s_waitcnt lgkmcnt(0)
    v_readfirstlane_b32 s60, v3
    s_nop 0
    s_cmp_ge_u32 s60, 4
    s_cbranch_scc1 L_spd_hs
    s_sleep 1
    s_add_u32 s62, s62, 1
    s_cmp_lt_u32 s62, 0x800000
    s_cbranch_scc1 L_sp_hs
L_spd_hs:
    s_branch L_p2d
L_nozf:
    s_add_u32 s61, s65, 245760
    s_add_u32 m0, s67, 16384
    s_nop 0
    buffer_load_dwordx4 v1, s[32:35], s61 offen offset:0 sc1 lds
    s_add_u32 m0, s67, 16384
    s_nop 0
    buffer_load_dwordx4 v1, s[32:35], s61 offen offset:1024 sc1 lds
    s_add_u32 m0, s67, 16384
    s_nop 0
    buffer_load_dwordx4 v1, s[32:35], s61 offen offset:2048 sc1 lds
    s_add_u32 m0, s67, 16384
    s_nop 0
    buffer_load_dwordx4 v1, s[32:35], s61 offen offset:3072 sc1 lds
    s_add_u32 m0, s67, 20480
    s_nop 0
    buffer_load_dwordx4 v2, s[32:35], s61 offen sc1 lds
    s_add_u32 s61, s65, 266240
    s_add_u32 m0, s67, 21504
    s_nop 0
    buffer_load_dwordx4 v1, s[32:35], s61 offen offset:0 sc1 lds
    s_add_u32 m0, s67, 21504
    s_nop 0
    buffer_load_dwordx4 v1, s[32:35], s61 offen offset:1024 sc1 lds
    s_add_u32 m0, s67, 21504
    s_nop 0
    buffer_load_dwordx4 v1, s[32:35], s61 offen offset:2048 sc1 lds
    s_add_u32 m0, s67, 21504
    s_nop 0
    buffer_load_dwordx4 v1, s[32:35], s61 offen offset:3072 sc1 lds
    s_add_u32 m0, s67, 25600
    s_nop 0
    buffer_load_dwordx4 v2, s[32:35], s61 offen sc1 lds
    s_add_u32 s61, s65, 286720
    s_add_u32 m0, s67, 26624
    s_nop 0
    buffer_load_dwordx4 v1, s[32:35], s61 offen offset:0 sc1 lds
    s_add_u32 m0, s67, 26624
    s_nop 0
    buffer_load_dwordx4 v1, s[32:35], s61 offen offset:1024 sc1 lds
    s_add_u32 m0, s67, 26624
    s_nop 0
    buffer_load_dwordx4 v1, s[32:35], s61 offen offset:2048 sc1 lds
    s_add_u32 m0, s67, 26624
    s_nop 0
    buffer_load_dwordx4 v1, s[32:35], s61 offen offset:3072 sc1 lds
    s_add_u32 m0, s67, 30720
    s_nop 0
    buffer_load_dwordx4 v2, s[32:35], s61 offen sc1 lds
    s_add_u32 s61, s65, 307200
    s_add_u32 m0, s67, 31744
    s_nop 0
    buffer_load_dwordx4 v1, s[32:35], s61 offen offset:0 sc1 lds
    s_add_u32 m0, s67, 31744
    s_nop 0
    buffer_load_dwordx4 v1, s[32:35], s61 offen offset:1024 sc1 lds
    s_add_u32 m0, s67, 31744
    s_nop 0
    buffer_load_dwordx4 v1, s[32:35], s61 offen offset:2048 sc1 lds
    s_add_u32 m0, s67, 31744
    s_nop 0
    buffer_load_dwordx4 v1, s[32:35], s61 offen offset:3072 sc1 lds
    s_add_u32 m0, s67, 35840
    s_nop 0
    buffer_load_dwordx4 v2, s[32:35], s61 offen sc1 lds
    s_add_u32 s61, s65, 0
    buffer_load_dwordx4 v[104:107], v1, s[32:35], s61 offen offset:0 sc1
    buffer_load_dwordx4 v[108:111], v1, s[32:35], s61 offen offset:1024 sc1
    buffer_load_dwordx4 v[112:115], v1, s[32:35], s61 offen offset:2048 sc1
    buffer_load_dwordx4 v[116:119], v1, s[32:35], s61 offen offset:3072 sc1
    buffer_load_dwordx4 v[120:123], v2, s[32:35], s61 offen sc1
    s_add_u32 s61, s65, 20480
    buffer_load_dwordx4 v[124:127], v1, s[32:35], s61 offen offset:0 sc1
    buffer_load_dwordx4 v[128:131], v1, s[32:35], s61 offen offset:1024 sc1
    buffer_load_dwordx4 v[132:135], v1, s[32:35], s61 offen offset:2048 sc1
    buffer_load_dwordx4 v[136:139], v1, s[32:35], s61 offen offset:3072 sc1
    buffer_load_dwordx4 v[140:143], v2, s[32:35], s61 offen sc1
    s_add_u32 s61, s65, 40960
    buffer_load_dwordx4 v[144:147], v1, s[32:35], s61 offen offset:0 sc1
    buffer_load_dwordx4 v[148:151], v1, s[32:35], s61 offen offset:1024 sc1
    buffer_load_dwordx4 v[152:155], v1, s[32:35], s61 offen offset:2048 sc1
    buffer_load_dwordx4 v[156:159], v1, s[32:35], s61 offen offset:3072 sc1
    buffer_load_dwordx4 v[160:163], v2, s[32:35], s61 offen sc1
L_p2d:
    s_add_u32 s61, s65, 327680
    s_add_u32 m0, s67, 0
    s_nop 0
    buffer_load_dwordx4 v1, s[32:35], s61 offen offset:0 sc1 lds
    s_add_u32 m0, s67, 0
    s_nop 0
    buffer_load_dwordx4 v1, s[32:35], s61 offen offset:1024 sc1 lds
    s_add_u32 m0, s67, 0
    s_nop 0
    buffer_load_dwordx4 v1, s[32:35], s61 offen offset:2048 sc1 lds
    s_add_u32 m0, s67, 0
    s_nop 0
    buffer_load_dwordx4 v1, s[32:35], s61 offen offset:3072 sc1 lds
    s_add_u32 m0, s67, 4096
    s_nop 0
    buffer_load_dwordx4 v2, s[32:35], s61 offen sc1 lds
    buffer_load_dword v168, v16, s[32:35], s68 offen sc1
    buffer_load_dword v170, v17, s[32:35], s68 offen sc1
    buffer_load_dword v172, v18, s[32:35], s68 offen sc1
    s_mov_b32 s62, 0
    s_cmp_eq_u32 s50, 0
    s_cbranch_scc0 L_sp0_p2
L_gp_p2:
    buffer_load_dword v3, v28, s[32:35], s59 offen sc1
    s_waitcnt vmcnt(0)
    v_cmp_eq_u32 vcc, 0, v3
    s_nop 0
    s_and_b32 s60, vcc_lo, 0xff
    s_cbranch_scc0 L_gpd_p2
    s_sleep 2
    s_add_u32 s62, s62, 1
    s_cmp_lt_u32 s62, 0x80000
    s_cbranch_scc1 L_gp_p2
L_gpd_p2:
    v_mov_b32 v3, 1
    ds_write_b32 v26, v3 offset:24
    s_branch L_spd_p2
L_sp0_p2:
    s_mov_b32 s62, 0
L_sp_p2:
    ds_read_b32 v3, v26 offset:24
    s_waitcnt lgkmcnt(0)
    v_readfirstlane_b32 s60, v3
    s_nop 0
    s_cmp_ge_u32 s60, 1
    s_cbranch_scc1 L_spd_p2
    s_sleep 1
    s_add_u32 s62, s62, 1
    s_cmp_lt_u32 s62, 0x800000
    s_cbranch_scc1 L_sp_p2
L_spd_p2:
    s_add_u32 s63, s64, 0
    buffer_load_dwordx4 v[40:43], v1, s[32:35], s63 offen offset:0 sc1
    buffer_load_dwordx4 v[44:47], v1, s[32:35], s63 offen offset:1024 sc1
    buffer_load_dwordx4 v[48:51], v1, s[32:35], s63 offen offset:2048 sc1
    buffer_load_dwordx4 v[52:55], v1, s[32:35], s63 offen offset:3072 sc1
    s_add_u32 s63, s64, 16384
    buffer_load_dwordx4 v[56:59], v1, s[32:35], s63 offen offset:0 sc1
    buffer_load_dwordx4 v[60:63], v1, s[32:35], s63 offen offset:1024 sc1
    buffer_load_dwordx4 v[64:67], v1, s[32:35], s63 offen offset:2048 sc1
    buffer_load_dwordx4 v[68:71], v1, s[32:35], s63 offen offset:3072 sc1
    s_add_u32 s63, s64, 32768
    buffer_load_dwordx4 v[72:75], v1, s[32:35], s63 offen offset:0 sc1
    buffer_load_dwordx4 v[76:79], v1, s[32:35], s63 offen offset:1024 sc1
    buffer_load_dwordx4 v[80:83], v1, s[32:35], s63 offen offset:2048 sc1
    buffer_load_dwordx4 v[84:87], v1, s[32:35], s63 offen offset:3072 sc1
    s_waitcnt vmcnt(8)
    v_mfma_f32_16x16x32_bf16 v[176:179], v[104:107], v[40:43], 0
    v_mfma_f32_16x16x32_bf16 v[196:199], v[104:107], v[44:47], 0
    s_add_u32 s63, s64, 49152
    buffer_load_dwordx4 v[88:91], v1, s[32:35], s63 offen offset:0 sc1
    v_mfma_f32_16x16x32_bf16 v[216:219], v[104:107], v[48:51], 0
    v_mfma_f32_16x16x32_bf16 v[236:239], v[104:107], v[52:55], 0
    buffer_load_dwordx4 v[92:95], v1, s[32:35], s63 offen offset:1024 sc1
    v_mfma_f32_16x16x32_bf16 v[180:183], v[108:111], v[40:43], 0
    v_mfma_f32_16x16x32_bf16 v[200:203], v[108:111], v[44:47], 0
    buffer_load_dwordx4 v[96:99], v1, s[32:35], s63 offen offset:2048 sc1
    v_mfma_f32_16x16x32_bf16 v[220:223], v[108:111], v[48:51], 0
    v_mfma_f32_16x16x32_bf16 v[240:243], v[108:111], v[52:55], 0
    buffer_load_dwordx4 v[100:103], v1, s[32:35], s63 offen offset:3072 sc1
    v_mfma_f32_16x16x32_bf16 v[184:187], v[112:115], v[40:43], 0
    v_mfma_f32_16x16x32_bf16 v[204:207], v[112:115], v[44:47], 0
    v_mfma_f32_16x16x32_bf16 v[224:227], v[112:115], v[48:51], 0
    v_mfma_f32_16x16x32_bf16 v[244:247], v[112:115], v[52:55], 0
    v_mfma_f32_16x16x32_bf16 v[188:191], v[116:119], v[40:43], 0
    v_mfma_f32_16x16x32_bf16 v[208:211], v[116:119], v[44:47], 0
    v_mfma_f32_16x16x32_bf16 v[228:231], v[116:119], v[48:51], 0
    v_mfma_f32_16x16x32_bf16 v[248:251], v[116:119], v[52:55], 0
    v_mfma_f32_16x16x32_bf16 v[192:195], v[120:123], v[40:43], 0
    v_mfma_f32_16x16x32_bf16 v[212:215], v[120:123], v[44:47], 0
    v_mfma_f32_16x16x32_bf16 v[232:235], v[120:123], v[48:51], 0
    v_mfma_f32_16x16x32_bf16 v[252:255], v[120:123], v[52:55], 0
    s_waitcnt vmcnt(8)
    v_mfma_f32_16x16x32_bf16 v[176:179], v[124:127], v[56:59], v[176:179]
    v_mfma_f32_16x16x32_bf16 v[196:199], v[124:127], v[60:63], v[196:199]
    s_add_u32 s63, s64, 65536
    buffer_load_dwordx4 v[40:43], v1, s[32:35], s63 offen offset:0 sc1
    v_mfma_f32_16x16x32_bf16 v[216:219], v[124:127], v[64:67], v[216:219]
    v_mfma_f32_16x16x32_bf16 v[236:239], v[124:127], v[68:71], v[236:239]
    buffer_load_dwordx4 v[44:47], v1, s[32:35], s63 offen offset:1024 sc1
    v_mfma_f32_16x16x32_bf16 v[180:183], v[128:131], v[56:59], v[180:183]
    v_mfma_f32_16x16x32_bf16 v[200:203], v[128:131], v[60:63], v[200:203]
    buffer_load_dwordx4 v[48:51], v1, s[32:35], s63 offen offset:2048 sc1
    v_mfma_f32_16x16x32_bf16 v[220:223], v[128:131], v[64:67], v[220:223]
    v_mfma_f32_16x16x32_bf16 v[240:243], v[128:131], v[68:71], v[240:243]
    buffer_load_dwordx4 v[52:55], v1, s[32:35], s63 offen offset:3072 sc1
    v_mfma_f32_16x16x32_bf16 v[184:187], v[132:135], v[56:59], v[184:187]
    v_mfma_f32_16x16x32_bf16 v[204:207], v[132:135], v[60:63], v[204:207]
    s_add_u32 s61, s65, 61440
    buffer_load_dwordx4 v[104:107], v1, s[32:35], s61 offen offset:0 sc1
    v_mfma_f32_16x16x32_bf16 v[224:227], v[132:135], v[64:67], v[224:227]
    v_mfma_f32_16x16x32_bf16 v[244:247], v[132:135], v[68:71], v[244:247]
    buffer_load_dwordx4 v[108:111], v1, s[32:35], s61 offen offset:1024 sc1
    v_mfma_f32_16x16x32_bf16 v[188:191], v[136:139], v[56:59], v[188:191]
    v_mfma_f32_16x16x32_bf16 v[208:211], v[136:139], v[60:63], v[208:211]
    buffer_load_dwordx4 v[112:115], v1, s[32:35], s61 offen offset:2048 sc1
    v_mfma_f32_16x16x32_bf16 v[228:231], v[136:139], v[64:67], v[228:231]
    v_mfma_f32_16x16x32_bf16 v[248:251], v[136:139], v[68:71], v[248:251]
    buffer_load_dwordx4 v[116:119], v1, s[32:35], s61 offen offset:3072 sc1
    v_mfma_f32_16x16x32_bf16 v[192:195], v[140:143], v[56:59], v[192:195]
    v_mfma_f32_16x16x32_bf16 v[212:215], v[140:143], v[60:63], v[212:215]
    buffer_load_dwordx4 v[120:123], v2, s[32:35], s61 offen sc1
    v_mfma_f32_16x16x32_bf16 v[232:235], v[140:143], v[64:67], v[232:235]
    v_mfma_f32_16x16x32_bf16 v[252:255], v[140:143], v[68:71], v[252:255]
    s_waitcnt vmcnt(13)
    v_mfma_f32_16x16x32_bf16 v[176:179], v[144:147], v[72:75], v[176:179]
    v_mfma_f32_16x16x32_bf16 v[196:199], v[144:147], v[76:79], v[196:199]
    s_add_u32 s63, s64, 81920
    buffer_load_dwordx4 v[56:59], v1, s[32:35], s63 offen offset:0 sc1
    v_mfma_f32_16x16x32_bf16 v[216:219], v[144:147], v[80:83], v[216:219]
    v_mfma_f32_16x16x32_bf16 v[236:239], v[144:147], v[84:87], v[236:239]
    buffer_load_dwordx4 v[60:63], v1, s[32:35], s63 offen offset:1024 sc1
    v_mfma_f32_16x16x32_bf16 v[180:183], v[148:151], v[72:75], v[180:183]
    v_mfma_f32_16x16x32_bf16 v[200:203], v[148:151], v[76:79], v[200:203]
    buffer_load_dwordx4 v[64:67], v1, s[32:35], s63 offen offset:2048 sc1
    v_mfma_f32_16x16x32_bf16 v[220:223], v[148:151], v[80:83], v[220:223]
    v_mfma_f32_16x16x32_bf16 v[240:243], v[148:151], v[84:87], v[240:243]
    buffer_load_dwordx4 v[68:71], v1, s[32:35], s63 offen offset:3072 sc1
    v_mfma_f32_16x16x32_bf16 v[184:187], v[152:155], v[72:75], v[184:187]
    v_mfma_f32_16x16x32_bf16 v[204:207], v[152:155], v[76:79], v[204:207]
    s_add_u32 s61, s65, 81920
    buffer_load_dwordx4 v[124:127], v1, s[32:35], s61 offen offset:0 sc1
    v_mfma_f32_16x16x32_bf16 v[224:227], v[152:155], v[80:83], v[224:227]
    v_mfma_f32_16x16x32_bf16 v[244:247], v[152:155], v[84:87], v[244:247]
    buffer_load_dwordx4 v[128:131], v1, s[32:35], s61 offen offset:1024 sc1
    v_mfma_f32_16x16x32_bf16 v[188:191], v[156:159], v[72:75], v[188:191]
    v_mfma_f32_16x16x32_bf16 v[208:211], v[156:159], v[76:79], v[208:211]
    buffer_load_dwordx4 v[132:135], v1, s[32:35], s61 offen offset:2048 sc1
    v_mfma_f32_16x16x32_bf16 v[228:231], v[156:159], v[80:83], v[228:231]
    v_mfma_f32_16x16x32_bf16 v[248:251], v[156:159], v[84:87], v[248:251]
    buffer_load_dwordx4 v[136:139], v1, s[32:35], s61 offen offset:3072 sc1
    v_mfma_f32_16x16x32_bf16 v[192:195], v[160:163], v[72:75], v[192:195]
    v_mfma_f32_16x16x32_bf16 v[212:215], v[160:163], v[76:79], v[212:215]
    buffer_load_dwordx4 v[140:143], v2, s[32:35], s61 offen sc1
    v_mfma_f32_16x16x32_bf16 v[232:235], v[160:163], v[80:83], v[232:235]
    v_mfma_f32_16x16x32_bf16 v[252:255], v[160:163], v[84:87], v[252:255]
    s_waitcnt vmcnt(9)
    v_mfma_f32_16x16x32_bf16 v[176:179], v[104:107], v[88:91], v[176:179]
    v_mfma_f32_16x16x32_bf16 v[196:199], v[104:107], v[92:95], v[196:199]
    s_add_u32 s63, s64, 98304
    buffer_load_dwordx4 v[72:75], v1, s[32:35], s63 offen offset:0 sc1
    v_mfma_f32_16x16x32_bf16 v[216:219], v[104:107], v[96:99], v[216:219]
    v_mfma_f32_16x16x32_bf16 v[236:239], v[104:107], v[100:103], v[236:239]
    buffer_load_dwordx4 v[76:79], v1, s[32:35], s63 offen offset:1024 sc1
    v_mfma_f32_16x16x32_bf16 v[180:183], v[108:111], v[88:91], v[180:183]
    v_mfma_f32_16x16x32_bf16 v[200:203], v[108:111], v[92:95], v[200:203]
    buffer_load_dwordx4 v[80:83], v1, s[32:35], s63 offen offset:2048 sc1
    v_mfma_f32_16x16x32_bf16 v[220:223], v[108:111], v[96:99], v[220:223]
    v_mfma_f32_16x16x32_bf16 v[240:243], v[108:111], v[100:103], v[240:243]
    buffer_load_dwordx4 v[84:87], v1, s[32:35], s63 offen offset:3072 sc1
    v_mfma_f32_16x16x32_bf16 v[184:187], v[112:115], v[88:91], v[184:187]
    v_mfma_f32_16x16x32_bf16 v[204:207], v[112:115], v[92:95], v[204:207]
    s_add_u32 s61, s65, 102400
    buffer_load_dwordx4 v[144:147], v1, s[32:35], s61 offen offset:0 sc1
    v_mfma_f32_16x16x32_bf16 v[224:227], v[112:115], v[96:99], v[224:227]
    v_mfma_f32_16x16x32_bf16 v[244:247], v[112:115], v[100:103], v[244:247]
    buffer_load_dwordx4 v[148:151], v1, s[32:35], s61 offen offset:1024 sc1
    v_mfma_f32_16x16x32_bf16 v[188:191], v[116:119], v[88:91], v[188:191]
    v_mfma_f32_16x16x32_bf16 v[208:211], v[116:119], v[92:95], v[208:211]
    buffer_load_dwordx4 v[152:155], v1, s[32:35], s61 offen offset:2048 sc1
    v_mfma_f32_16x16x32_bf16 v[228:231], v[116:119], v[96:99], v[228:231]
    v_mfma_f32_16x16x32_bf16 v[248:251], v[116:119], v[100:103], v[248:251]
    buffer_load_dwordx4 v[156:159], v1, s[32:35], s61 offen offset:3072 sc1
    v_mfma_f32_16x16x32_bf16 v[192:195], v[120:123], v[88:91], v[192:195]
    v_mfma_f32_16x16x32_bf16 v[212:215], v[120:123], v[92:95], v[212:215]
    buffer_load_dwordx4 v[160:163], v2, s[32:35], s61 offen sc1
    v_mfma_f32_16x16x32_bf16 v[232:235], v[120:123], v[96:99], v[232:235]
    v_mfma_f32_16x16x32_bf16 v[252:255], v[120:123], v[100:103], v[252:255]
    s_waitcnt vmcnt(9)
    v_mfma_f32_16x16x32_bf16 v[176:179], v[124:127], v[40:43], v[176:179]
    v_mfma_f32_16x16x32_bf16 v[196:199], v[124:127], v[44:47], v[196:199]
    s_add_u32 s63, s64, 114688
    buffer_load_dwordx4 v[88:91], v1, s[32:35], s63 offen offset:0 sc1
    v_mfma_f32_16x16x32_bf16 v[216:219], v[124:127], v[48:51], v[216:219]
    v_mfma_f32_16x16x32_bf16 v[236:239], v[124:127], v[52:55], v[236:239]
    buffer_load_dwordx4 v[92:95], v1, s[32:35], s63 offen offset:1024 sc1
    v_mfma_f32_16x16x32_bf16 v[180:183], v[128:131], v[40:43], v[180:183]
    v_mfma_f32_16x16x32_bf16 v[200:203], v[128:131], v[44:47], v[200:203]
    buffer_load_dwordx4 v[96:99], v1, s[32:35], s63 offen offset:2048 sc1
    v_mfma_f32_16x16x32_bf16 v[220:223], v[128:131], v[48:51], v[220:223]
    v_mfma_f32_16x16x32_bf16 v[240:243], v[128:131], v[52:55], v[240:243]
    buffer_load_dwordx4 v[100:103], v1, s[32:35], s63 offen offset:3072 sc1
    v_mfma_f32_16x16x32_bf16 v[184:187], v[132:135], v[40:43], v[184:187]
    v_mfma_f32_16x16x32_bf16 v[204:207], v[132:135], v[44:47], v[204:207]
    s_add_u32 s61, s65, 122880
    buffer_load_dwordx4 v[104:107], v1, s[32:35], s61 offen offset:0 sc1
    v_mfma_f32_16x16x32_bf16 v[224:227], v[132:135], v[48:51], v[224:227]
    v_mfma_f32_16x16x32_bf16 v[244:247], v[132:135], v[52:55], v[244:247]
    buffer_load_dwordx4 v[108:111], v1, s[32:35], s61 offen offset:1024 sc1
    v_mfma_f32_16x16x32_bf16 v[188:191], v[136:139], v[40:43], v[188:191]
    v_mfma_f32_16x16x32_bf16 v[208:211], v[136:139], v[44:47], v[208:211]
    buffer_load_dwordx4 v[112:115], v1, s[32:35], s61 offen offset:2048 sc1
    v_mfma_f32_16x16x32_bf16 v[228:231], v[136:139], v[48:51], v[228:231]
    v_mfma_f32_16x16x32_bf16 v[248:251], v[136:139], v[52:55], v[248:251]
    buffer_load_dwordx4 v[116:119], v1, s[32:35], s61 offen offset:3072 sc1
    v_mfma_f32_16x16x32_bf16 v[192:195], v[140:143], v[40:43], v[192:195]
    v_mfma_f32_16x16x32_bf16 v[212:215], v[140:143], v[44:47], v[212:215]
    buffer_load_dwordx4 v[120:123], v2, s[32:35], s61 offen sc1
    v_mfma_f32_16x16x32_bf16 v[232:235], v[140:143], v[48:51], v[232:235]
    v_mfma_f32_16x16x32_bf16 v[252:255], v[140:143], v[52:55], v[252:255]
    s_waitcnt vmcnt(9)
    v_mfma_f32_16x16x32_bf16 v[176:179], v[144:147], v[56:59], v[176:179]
    v_mfma_f32_16x16x32_bf16 v[196:199], v[144:147], v[60:63], v[196:199]
    s_add_u32 s63, s64, 131072
    buffer_load_dwordx4 v[40:43], v1, s[32:35], s63 offen offset:0 sc1
    v_mfma_f32_16x16x32_bf16 v[216:219], v[144:147], v[64:67], v[216:219]
    v_mfma_f32_16x16x32_bf16 v[236:239], v[144:147], v[68:71], v[236:239]
    buffer_load_dwordx4 v[44:47], v1, s[32:35], s63 offen offset:1024 sc1
    v_mfma_f32_16x16x32_bf16 v[180:183], v[148:151], v[56:59], v[180:183]
    v_mfma_f32_16x16x32_bf16 v[200:203], v[148:151], v[60:63], v[200:203]
    buffer_load_dwordx4 v[48:51], v1, s[32:35], s63 offen offset:2048 sc1
    v_mfma_f32_16x16x32_bf16 v[220:223], v[148:151], v[64:67], v[220:223]
    v_mfma_f32_16x16x32_bf16 v[240:243], v[148:151], v[68:71], v[240:243]
    buffer_load_dwordx4 v[52:55], v1, s[32:35], s63 offen offset:3072 sc1
    v_mfma_f32_16x16x32_bf16 v[184:187], v[152:155], v[56:59], v[184:187]
    v_mfma_f32_16x16x32_bf16 v[204:207], v[152:155], v[60:63], v[204:207]
    s_add_u32 s61, s65, 143360
    buffer_load_dwordx4 v[124:127], v1, s[32:35], s61 offen offset:0 sc1
    v_mfma_f32_16x16x32_bf16 v[224:227], v[152:155], v[64:67], v[224:227]
    v_mfma_f32_16x16x32_bf16 v[244:247], v[152:155], v[68:71], v[244:247]
    buffer_load_dwordx4 v[128:131], v1, s[32:35], s61 offen offset:1024 sc1
    v_mfma_f32_16x16x32_bf16 v[188:191], v[156:159], v[56:59], v[188:191]
    v_mfma_f32_16x16x32_bf16 v[208:211], v[156:159], v[60:63], v[208:211]
    buffer_load_dwordx4 v[132:135], v1, s[32:35], s61 offen offset:2048 sc1
    v_mfma_f32_16x16x32_bf16 v[228:231], v[156:159], v[64:67], v[228:231]
    v_mfma_f32_16x16x32_bf16 v[248:251], v[156:159], v[68:71], v[248:251]
    buffer_load_dwordx4 v[136:139], v1, s[32:35], s61 offen offset:3072 sc1
    v_mfma_f32_16x16x32_bf16 v[192:195], v[160:163], v[56:59], v[192:195]
    v_mfma_f32_16x16x32_bf16 v[212:215], v[160:163], v[60:63], v[212:215]
    buffer_load_dwordx4 v[140:143], v2, s[32:35], s61 offen sc1
    v_mfma_f32_16x16x32_bf16 v[232:235], v[160:163], v[64:67], v[232:235]
    v_mfma_f32_16x16x32_bf16 v[252:255], v[160:163], v[68:71], v[252:255]
    s_waitcnt vmcnt(9)
    v_mfma_f32_16x16x32_bf16 v[176:179], v[104:107], v[72:75], v[176:179]
    v_mfma_f32_16x16x32_bf16 v[196:199], v[104:107], v[76:79], v[196:199]
    s_add_u32 s63, s64, 147456
    buffer_load_dwordx4 v[56:59], v1, s[32:35], s63 offen offset:0 sc1
    v_mfma_f32_16x16x32_bf16 v[216:219], v[104:107], v[80:83], v[216:219]
    v_mfma_f32_16x16x32_bf16 v[236:239], v[104:107], v[84:87], v[236:239]
    buffer_load_dwordx4 v[60:63], v1, s[32:35], s63 offen offset:1024 sc1
    v_mfma_f32_16x16x32_bf16 v[180:183], v[108:111], v[72:75], v[180:183]
    v_mfma_f32_16x16x32_bf16 v[200:203], v[108:111], v[76:79], v[200:203]
    buffer_load_dwordx4 v[64:67], v1, s[32:35], s63 offen offset:2048 sc1
    v_mfma_f32_16x16x32_bf16 v[220:223], v[108:111], v[80:83], v[220:223]
    v_mfma_f32_16x16x32_bf16 v[240:243], v[108:111], v[84:87], v[240:243]
    buffer_load_dwordx4 v[68:71], v1, s[32:35], s63 offen offset:3072 sc1
    v_mfma_f32_16x16x32_bf16 v[184:187], v[112:115], v[72:75], v[184:187]
    v_mfma_f32_16x16x32_bf16 v[204:207], v[112:115], v[76:79], v[204:207]
    s_add_u32 s61, s65, 163840
    buffer_load_dwordx4 v[144:147], v1, s[32:35], s61 offen offset:0 sc1
    v_mfma_f32_16x16x32_bf16 v[224:227], v[112:115], v[80:83], v[224:227]
    v_mfma_f32_16x16x32_bf16 v[244:247], v[112:115], v[84:87], v[244:247]
    buffer_load_dwordx4 v[148:151], v1, s[32:35], s61 offen offset:1024 sc1
    v_mfma_f32_16x16x32_bf16 v[188:191], v[116:119], v[72:75], v[188:191]
    v_mfma_f32_16x16x32_bf16 v[208:211], v[116:119], v[76:79], v[208:211]
    buffer_load_dwordx4 v[152:155], v1, s[32:35], s61 offen offset:2048 sc1
    v_mfma_f32_16x16x32_bf16 v[228:231], v[116:119], v[80:83], v[228:231]
    v_mfma_f32_16x16x32_bf16 v[248:251], v[116:119], v[84:87], v[248:251]
    buffer_load_dwordx4 v[156:159], v1, s[32:35], s61 offen offset:3072 sc1
    v_mfma_f32_16x16x32_bf16 v[192:195], v[120:123], v[72:75], v[192:195]
    v_mfma_f32_16x16x32_bf16 v[212:215], v[120:123], v[76:79], v[212:215]
    buffer_load_dwordx4 v[160:163], v2, s[32:35], s61 offen sc1
    v_mfma_f32_16x16x32_bf16 v[232:235], v[120:123], v[80:83], v[232:235]
    v_mfma_f32_16x16x32_bf16 v[252:255], v[120:123], v[84:87], v[252:255]
    s_waitcnt vmcnt(9)
    v_mfma_f32_16x16x32_bf16 v[176:179], v[124:127], v[88:91], v[176:179]
    v_mfma_f32_16x16x32_bf16 v[196:199], v[124:127], v[92:95], v[196:199]
    s_add_u32 s63, s64, 163840
    buffer_load_dwordx4 v[72:75], v1, s[32:35], s63 offen offset:0 sc1
    v_mfma_f32_16x16x32_bf16 v[216:219], v[124:127], v[96:99], v[216:219]
    v_mfma_f32_16x16x32_bf16 v[236:239], v[124:127], v[100:103], v[236:239]
    buffer_load_dwordx4 v[76:79], v1, s[32:35], s63 offen offset:1024 sc1
    v_mfma_f32_16x16x32_bf16 v[180:183], v[128:131], v[88:91], v[180:183]
    v_mfma_f32_16x16x32_bf16 v[200:203], v[128:131], v[92:95], v[200:203]
    buffer_load_dwordx4 v[80:83], v1, s[32:35], s63 offen offset:2048 sc1
    v_mfma_f32_16x16x32_bf16 v[220:223], v[128:131], v[96:99], v[220:223]
    v_mfma_f32_16x16x32_bf16 v[240:243], v[128:131], v[100:103], v[240:243]
    buffer_load_dwordx4 v[84:87], v1, s[32:35], s63 offen offset:3072 sc1
    v_mfma_f32_16x16x32_bf16 v[184:187], v[132:135], v[88:91], v[184:187]
    v_mfma_f32_16x16x32_bf16 v[204:207], v[132:135], v[92:95], v[204:207]
    s_add_u32 s61, s65, 184320
    buffer_load_dwordx4 v[104:107], v1, s[32:35], s61 offen offset:0 sc1
    v_mfma_f32_16x16x32_bf16 v[224:227], v[132:135], v[96:99], v[224:227]
    v_mfma_f32_16x16x32_bf16 v[244:247], v[132:135], v[100:103], v[244:247]
    buffer_load_dwordx4 v[108:111], v1, s[32:35], s61 offen offset:1024 sc1
    v_mfma_f32_16x16x32_bf16 v[188:191], v[136:139], v[88:91], v[188:191]
    v_mfma_f32_16x16x32_bf16 v[208:211], v[136:139], v[92:95], v[208:211]
    buffer_load_dwordx4 v[112:115], v1, s[32:35], s61 offen offset:2048 sc1
    v_mfma_f32_16x16x32_bf16 v[228:231], v[136:139], v[96:99], v[228:231]
    v_mfma_f32_16x16x32_bf16 v[248:251], v[136:139], v[100:103], v[248:251]
    buffer_load_dwordx4 v[116:119], v1, s[32:35], s61 offen offset:3072 sc1
    v_mfma_f32_16x16x32_bf16 v[192:195], v[140:143], v[88:91], v[192:195]
    v_mfma_f32_16x16x32_bf16 v[212:215], v[140:143], v[92:95], v[212:215]
    buffer_load_dwordx4 v[120:123], v2, s[32:35], s61 offen sc1
    v_mfma_f32_16x16x32_bf16 v[232:235], v[140:143], v[96:99], v[232:235]
    v_mfma_f32_16x16x32_bf16 v[252:255], v[140:143], v[100:103], v[252:255]
    s_waitcnt vmcnt(9)
    v_mfma_f32_16x16x32_bf16 v[176:179], v[144:147], v[40:43], v[176:179]
    v_mfma_f32_16x16x32_bf16 v[196:199], v[144:147], v[44:47], v[196:199]
    buffer_load_dword v29, v28, s[32:35], s59 offen sc1
    v_mfma_f32_16x16x32_bf16 v[216:219], v[144:147], v[48:51], v[216:219]
    v_mfma_f32_16x16x32_bf16 v[236:239], v[144:147], v[52:55], v[236:239]
    s_add_u32 s63, s64, 180224
    buffer_load_dwordx4 v[88:91], v1, s[32:35], s63 offen offset:0 sc1
    v_mfma_f32_16x16x32_bf16 v[180:183], v[148:151], v[40:43], v[180:183]
    v_mfma_f32_16x16x32_bf16 v[200:203], v[148:151], v[44:47], v[200:203]
    buffer_load_dwordx4 v[92:95], v1, s[32:35], s63 offen offset:1024 sc1
    v_mfma_f32_16x16x32_bf16 v[220:223], v[148:151], v[48:51], v[220:223]
    v_mfma_f32_16x16x32_bf16 v[240:243], v[148:151], v[52:55], v[240:243]
    buffer_load_dwordx4 v[96:99], v1, s[32:35], s63 offen offset:2048 sc1
    v_mfma_f32_16x16x32_bf16 v[184:187], v[152:155], v[40:43], v[184:187]
    v_mfma_f32_16x16x32_bf16 v[204:207], v[152:155], v[44:47], v[204:207]
    buffer_load_dwordx4 v[100:103], v1, s[32:35], s63 offen offset:3072 sc1
    v_mfma_f32_16x16x32_bf16 v[224:227], v[152:155], v[48:51], v[224:227]
    v_mfma_f32_16x16x32_bf16 v[244:247], v[152:155], v[52:55], v[244:247]
    s_add_u32 s61, s65, 204800
    buffer_load_dwordx4 v[124:127], v1, s[32:35], s61 offen offset:0 sc1
    v_mfma_f32_16x16x32_bf16 v[188:191], v[156:159], v[40:43], v[188:191]
    v_mfma_f32_16x16x32_bf16 v[208:211], v[156:159], v[44:47], v[208:211]
    buffer_load_dwordx4 v[128:131], v1, s[32:35], s61 offen offset:1024 sc1
    v_mfma_f32_16x16x32_bf16 v[228:231], v[156:159], v[48:51], v[228:231]
    v_mfma_f32_16x16x32_bf16 v[248:251], v[156:159], v[52:55], v[248:251]
    buffer_load_dwordx4 v[132:135], v1, s[32:35], s61 offen offset:2048 sc1
    v_mfma_f32_16x16x32_bf16 v[192:195], v[160:163], v[40:43], v[192:195]
    v_mfma_f32_16x16x32_bf16 v[212:215], v[160:163], v[44:47], v[212:215]
    buffer_load_dwordx4 v[136:139], v1, s[32:35], s61 offen offset:3072 sc1
    v_mfma_f32_16x16x32_bf16 v[232:235], v[160:163], v[48:51], v[232:235]
    v_mfma_f32_16x16x32_bf16 v[252:255], v[160:163], v[52:55], v[252:255]
    buffer_load_dwordx4 v[140:143], v2, s[32:35], s61 offen sc1
    s_waitcnt vmcnt(9)
    s_mov_b32 s62, 0
L_ob_chk:
    v_cmp_ne_u32 vcc, 2, v29
    s_nop 0
    s_and_b32 s60, vcc_lo, 0xff
    s_cbranch_scc0 L_ob_ok
    s_sleep 1
    buffer_load_dword v29, v28, s[32:35], s59 offen sc1
    s_add_u32 s62, s62, 1
    s_cmp_lt_u32 s62, 0x80000
    s_waitcnt vmcnt(0)
    s_cbranch_scc1 L_ob_chk
L_ob_ok:
    v_mfma_f32_16x16x32_bf16 v[176:179], v[104:107], v[56:59], v[176:179]
    v_mfma_f32_16x16x32_bf16 v[196:199], v[104:107], v[60:63], v[196:199]
    s_add_u32 s63, s64, 196608
    buffer_load_dwordx4 v[40:43], v1, s[32:35], s63 offen offset:0 sc1
    v_mfma_f32_16x16x32_bf16 v[216:219], v[104:107], v[64:67], v[216:219]
    v_mfma_f32_16x16x32_bf16 v[236:239], v[104:107], v[68:71], v[236:239]
    buffer_load_dwordx4 v[44:47], v1, s[32:35], s63 offen offset:1024 sc1
    v_mfma_f32_16x16x32_bf16 v[180:183], v[108:111], v[56:59], v[180:183]
    v_mfma_f32_16x16x32_bf16 v[200:203], v[108:111], v[60:63], v[200:203]
    buffer_load_dwordx4 v[48:51], v1, s[32:35], s63 offen offset:2048 sc1
    v_mfma_f32_16x16x32_bf16 v[220:223], v[108:111], v[64:67], v[220:223]
    v_mfma_f32_16x16x32_bf16 v[240:243], v[108:111], v[68:71], v[240:243]
    buffer_load_dwordx4 v[52:55], v1, s[32:35], s63 offen offset:3072 sc1
    v_mfma_f32_16x16x32_bf16 v[184:187], v[112:115], v[56:59], v[184:187]
    v_mfma_f32_16x16x32_bf16 v[204:207], v[112:115], v[60:63], v[204:207]
    s_add_u32 s61, s65, 225280
    buffer_load_dwordx4 v[144:147], v1, s[32:35], s61 offen offset:0 sc1
    v_mfma_f32_16x16x32_bf16 v[224:227], v[112:115], v[64:67], v[224:227]
    v_mfma_f32_16x16x32_bf16 v[244:247], v[112:115], v[68:71], v[244:247]
    buffer_load_dwordx4 v[148:151], v1, s[32:35], s61 offen offset:1024 sc1
    v_mfma_f32_16x16x32_bf16 v[188:191], v[116:119], v[56:59], v[188:191]
    v_mfma_f32_16x16x32_bf16 v[208:211], v[116:119], v[60:63], v[208:211]
    buffer_load_dwordx4 v[152:155], v1, s[32:35], s61 offen offset:2048 sc1
    v_mfma_f32_16x16x32_bf16 v[228:231], v[116:119], v[64:67], v[228:231]
    v_mfma_f32_16x16x32_bf16 v[248:251], v[116:119], v[68:71], v[248:251]
    buffer_load_dwordx4 v[156:159], v1, s[32:35], s61 offen offset:3072 sc1
    v_mfma_f32_16x16x32_bf16 v[192:195], v[120:123], v[56:59], v[192:195]
    v_mfma_f32_16x16x32_bf16 v[212:215], v[120:123], v[60:63], v[212:215]
    buffer_load_dwordx4 v[160:163], v2, s[32:35], s61 offen sc1
    v_mfma_f32_16x16x32_bf16 v[232:235], v[120:123], v[64:67], v[232:235]
    v_mfma_f32_16x16x32_bf16 v[252:255], v[120:123], v[68:71], v[252:255]
    s_waitcnt vmcnt(9)
    v_mfma_f32_16x16x32_bf16 v[176:179], v[124:127], v[72:75], v[176:179]
    v_mfma_f32_16x16x32_bf16 v[196:199], v[124:127], v[76:79], v[196:199]
    s_add_u32 s63, s64, 212992
    buffer_load_dwordx4 v[56:59], v1, s[32:35], s63 offen offset:0 sc1
    v_mfma_f32_16x16x32_bf16 v[216:219], v[124:127], v[80:83], v[216:219]
    v_mfma_f32_16x16x32_bf16 v[236:239], v[124:127], v[84:87], v[236:239]
    buffer_load_dwordx4 v[60:63], v1, s[32:35], s63 offen offset:1024 sc1
    v_mfma_f32_16x16x32_bf16 v[180:183], v[128:131], v[72:75], v[180:183]
    v_mfma_f32_16x16x32_bf16 v[200:203], v[128:131], v[76:79], v[200:203]
    buffer_load_dwordx4 v[64:67], v1, s[32:35], s63 offen offset:2048 sc1
    v_mfma_f32_16x16x32_bf16 v[220:223], v[128:131], v[80:83], v[220:223]
    v_mfma_f32_16x16x32_bf16 v[240:243], v[128:131], v[84:87], v[240:243]
    buffer_load_dwordx4 v[68:71], v1, s[32:35], s63 offen offset:3072 sc1
    v_mfma_f32_16x16x32_bf16 v[184:187], v[132:135], v[72:75], v[184:187]
    v_mfma_f32_16x16x32_bf16 v[204:207], v[132:135], v[76:79], v[204:207]
    v_mfma_f32_16x16x32_bf16 v[224:227], v[132:135], v[80:83], v[224:227]
    v_mfma_f32_16x16x32_bf16 v[244:247], v[132:135], v[84:87], v[244:247]
    v_mfma_f32_16x16x32_bf16 v[188:191], v[136:139], v[72:75], v[188:191]
    v_mfma_f32_16x16x32_bf16 v[208:211], v[136:139], v[76:79], v[208:211]
    v_mfma_f32_16x16x32_bf16 v[228:231], v[136:139], v[80:83], v[228:231]
    v_mfma_f32_16x16x32_bf16 v[248:251], v[136:139], v[84:87], v[248:251]
    v_mfma_f32_16x16x32_bf16 v[192:195], v[140:143], v[72:75], v[192:195]
    v_mfma_f32_16x16x32_bf16 v[212:215], v[140:143], v[76:79], v[212:215]
    v_mfma_f32_16x16x32_bf16 v[232:235], v[140:143], v[80:83], v[232:235]
    v_mfma_f32_16x16x32_bf16 v[252:255], v[140:143], v[84:87], v[252:255]
    s_waitcnt vmcnt(4)
    ds_read_b128 v[104:107], v27 offset:16384
    ds_read_b128 v[108:111], v27 offset:17408
    ds_read_b128 v[112:115], v27 offset:18432
    ds_read_b128 v[116:119], v27 offset:19456
    ds_read_b128 v[120:123], v27 offset:20480
    v_mfma_f32_16x16x32_bf16 v[176:179], v[144:147], v[88:91], v[176:179]
    v_mfma_f32_16x16x32_bf16 v[196:199], v[144:147], v[92:95], v[196:199]
    s_add_u32 s63, s64, 229376
    buffer_load_dwordx4 v[72:75], v1, s[32:35], s63 offen offset:0 sc1
    v_mfma_f32_16x16x32_bf16 v[216:219], v[144:147], v[96:99], v[216:219]
    v_mfma_f32_16x16x32_bf16 v[236:239], v[144:147], v[100:103], v[236:239]
    buffer_load_dwordx4 v[76:79], v1, s[32:35], s63 offen offset:1024 sc1
    v_mfma_f32_16x16x32_bf16 v[180:183], v[148:151], v[88:91], v[180:183]
    v_mfma_f32_16x16x32_bf16 v[200:203], v[148:151], v[92:95], v[200:203]
    buffer_load_dwordx4 v[80:83], v1, s[32:35], s63 offen offset:2048 sc1
    v_mfma_f32_16x16x32_bf16 v[220:223], v[148:151], v[96:99], v[220:223]
    v_mfma_f32_16x16x32_bf16 v[240:243], v[148:151], v[100:103], v[240:243]
    buffer_load_dwordx4 v[84:87], v1, s[32:35], s63 offen offset:3072 sc1
    v_mfma_f32_16x16x32_bf16 v[184:187], v[152:155], v[88:91], v[184:187]
    v_mfma_f32_16x16x32_bf16 v[204:207], v[152:155], v[92:95], v[204:207]
    v_mfma_f32_16x16x32_bf16 v[224:227], v[152:155], v[96:99], v[224:227]
    v_mfma_f32_16x16x32_bf16 v[244:247], v[152:155], v[100:103], v[244:247]
    v_mfma_f32_16x16x32_bf16 v[188:191], v[156:159], v[88:91], v[188:191]
    v_mfma_f32_16x16x32_bf16 v[208:211], v[156:159], v[92:95], v[208:211]
    v_mfma_f32_16x16x32_bf16 v[228:231], v[156:159], v[96:99], v[228:231]
    v_mfma_f32_16x16x32_bf16 v[248:251], v[156:159], v[100:103], v[248:251]
    v_mfma_f32_16x16x32_bf16 v[192:195], v[160:163], v[88:91], v[192:195]
    v_mfma_f32_16x16x32_bf16 v[212:215], v[160:163], v[92:95], v[212:215]
    v_mfma_f32_16x16x32_bf16 v[232:235], v[160:163], v[96:99], v[232:235]
    v_mfma_f32_16x16x32_bf16 v[252:255], v[160:163], v[100:103], v[252:255]
    s_waitcnt lgkmcnt(0)
    ds_read_b128 v[124:127], v27 offset:21504
    ds_read_b128 v[128:131], v27 offset:22528
    ds_read_b128 v[132:135], v27 offset:23552
    ds_read_b128 v[136:139], v27 offset:24576
    ds_read_b128 v[140:143], v27 offset:25600
    v_mfma_f32_16x16x32_bf16 v[176:179], v[104:107], v[40:43], v[176:179]
    v_mfma_f32_16x16x32_bf16 v[196:199], v[104:107], v[44:47], v[196:199]
    s_add_u32 s63, s64, 245760
    buffer_load_dwordx4 v[88:91], v1, s[32:35], s63 offen offset:0 sc1
    v_mfma_f32_16x16x32_bf16 v[216:219], v[104:107], v[48:51], v[216:219]
    v_mfma_f32_16x16x32_bf16 v[236:239], v[104:107], v[52:55], v[236:239]
    buffer_load_dwordx4 v[92:95], v1, s[32:35], s63 offen offset:1024 sc1
    v_mfma_f32_16x16x32_bf16 v[180:183], v[108:111], v[40:43], v[180:183]
    v_mfma_f32_16x16x32_bf16 v[200:203], v[108:111], v[44:47], v[200:203]
    buffer_load_dwordx4 v[96:99], v1, s[32:35], s63 offen offset:2048 sc1
    v_mfma_f32_16x16x32_bf16 v[220:223], v[108:111], v[48:51], v[220:223]
    v_mfma_f32_16x16x32_bf16 v[240:243], v[108:111], v[52:55], v[240:243]
    buffer_load_dwordx4 v[100:103], v1, s[32:35], s63 offen offset:3072 sc1
    v_mfma_f32_16x16x32_bf16 v[184:187], v[112:115], v[40:43], v[184:187]
    v_mfma_f32_16x16x32_bf16 v[204:207], v[112:115], v[44:47], v[204:207]
    v_mfma_f32_16x16x32_bf16 v[224:227], v[112:115], v[48:51], v[224:227]
    v_mfma_f32_16x16x32_bf16 v[244:247], v[112:115], v[52:55], v[244:247]
    v_mfma_f32_16x16x32_bf16 v[188:191], v[116:119], v[40:43], v[188:191]
    v_mfma_f32_16x16x32_bf16 v[208:211], v[116:119], v[44:47], v[208:211]
    v_mfma_f32_16x16x32_bf16 v[228:231], v[116:119], v[48:51], v[228:231]
    v_mfma_f32_16x16x32_bf16 v[248:251], v[116:119], v[52:55], v[248:251]
    v_mfma_f32_16x16x32_bf16 v[192:195], v[120:123], v[40:43], v[192:195]
    v_mfma_f32_16x16x32_bf16 v[212:215], v[120:123], v[44:47], v[212:215]
    v_mfma_f32_16x16x32_bf16 v[232:235], v[120:123], v[48:51], v[232:235]
    v_mfma_f32_16x16x32_bf16 v[252:255], v[120:123], v[52:55], v[252:255]
    s_waitcnt vmcnt(8)
    s_waitcnt lgkmcnt(0)
    ds_read_b128 v[144:147], v27 offset:26624
    ds_read_b128 v[148:151], v27 offset:27648
    ds_read_b128 v[152:155], v27 offset:28672
    ds_read_b128 v[156:159], v27 offset:29696
    ds_read_b128 v[160:163], v27 offset:30720
    v_mfma_f32_16x16x32_bf16 v[176:179], v[124:127], v[56:59], v[176:179]
    v_mfma_f32_16x16x32_bf16 v[196:199], v[124:127], v[60:63], v[196:199]
    s_add_u32 s63, s64, 262144
    buffer_load_dwordx4 v[40:43], v1, s[32:35], s63 offen offset:0 sc1
    v_mfma_f32_16x16x32_bf16 v[216:219], v[124:127], v[64:67], v[216:219]
    v_mfma_f32_16x16x32_bf16 v[236:239], v[124:127], v[68:71], v[236:239]
    buffer_load_dwordx4 v[44:47], v1, s[32:35], s63 offen offset:1024 sc1
    v_mfma_f32_16x16x32_bf16 v[180:183], v[128:131], v[56:59], v[180:183]
    v_mfma_f32_16x16x32_bf16 v[200:203], v[128:131], v[60:63], v[200:203]
    buffer_load_dwordx4 v[48:51], v1, s[32:35], s63 offen offset:2048 sc1
    v_mfma_f32_16x16x32_bf16 v[220:223], v[128:131], v[64:67], v[220:223]
    v_mfma_f32_16x16x32_bf16 v[240:243], v[128:131], v[68:71], v[240:243]
    buffer_load_dwordx4 v[52:55], v1, s[32:35], s63 offen offset:3072 sc1
    v_mfma_f32_16x16x32_bf16 v[184:187], v[132:135], v[56:59], v[184:187]
    v_mfma_f32_16x16x32_bf16 v[204:207], v[132:135], v[60:63], v[204:207]
    v_mfma_f32_16x16x32_bf16 v[224:227], v[132:135], v[64:67], v[224:227]
    v_mfma_f32_16x16x32_bf16 v[244:247], v[132:135], v[68:71], v[244:247]
    v_mfma_f32_16x16x32_bf16 v[188:191], v[136:139], v[56:59], v[188:191]
    v_mfma_f32_16x16x32_bf16 v[208:211], v[136:139], v[60:63], v[208:211]
    v_mfma_f32_16x16x32_bf16 v[228:231], v[136:139], v[64:67], v[228:231]
    v_mfma_f32_16x16x32_bf16 v[248:251], v[136:139], v[68:71], v[248:251]
    v_mfma_f32_16x16x32_bf16 v[192:195], v[140:143], v[56:59], v[192:195]
    v_mfma_f32_16x16x32_bf16 v[212:215], v[140:143], v[60:63], v[212:215]
    v_mfma_f32_16x16x32_bf16 v[232:235], v[140:143], v[64:67], v[232:235]
    v_mfma_f32_16x16x32_bf16 v[252:255], v[140:143], v[68:71], v[252:255]
    s_waitcnt vmcnt(8)
    s_waitcnt lgkmcnt(0)
    ds_read_b128 v[104:107], v27 offset:31744
    ds_read_b128 v[108:111], v27 offset:32768
    ds_read_b128 v[112:115], v27 offset:33792
    ds_read_b128 v[116:119], v27 offset:34816
    ds_read_b128 v[120:123], v27 offset:35840
    v_mfma_f32_16x16x32_bf16 v[176:179], v[144:147], v[72:75], v[176:179]
    v_mfma_f32_16x16x32_bf16 v[196:199], v[144:147], v[76:79], v[196:199]
    buffer_load_dwordx4 v[32:35], v13, s[20:23], s66 offen
    v_mfma_f32_16x16x32_bf16 v[216:219], v[144:147], v[80:83], v[216:219]
    v_mfma_f32_16x16x32_bf16 v[236:239], v[144:147], v[84:87], v[236:239]
    buffer_load_dwordx4 v[36:39], v14, s[20:23], s66 offen
    v_mfma_f32_16x16x32_bf16 v[180:183], v[148:151], v[72:75], v[180:183]
    v_mfma_f32_16x16x32_bf16 v[200:203], v[148:151], v[76:79], v[200:203]
    buffer_load_dwordx4 v[20:23], v15, s[20:23], s66 offen
    v_mfma_f32_16x16x32_bf16 v[220:223], v[148:151], v[80:83], v[220:223]
    v_mfma_f32_16x16x32_bf16 v[240:243], v[148:151], v[84:87], v[240:243]
    v_mfma_f32_16x16x32_bf16 v[184:187], v[152:155], v[72:75], v[184:187]
    v_mfma_f32_16x16x32_bf16 v[204:207], v[152:155], v[76:79], v[204:207]
    v_mfma_f32_16x16x32_bf16 v[224:227], v[152:155], v[80:83], v[224:227]
    v_mfma_f32_16x16x32_bf16 v[244:247], v[152:155], v[84:87], v[244:247]
    v_mfma_f32_16x16x32_bf16 v[188:191], v[156:159], v[72:75], v[188:191]
    v_mfma_f32_16x16x32_bf16 v[208:211], v[156:159], v[76:79], v[208:211]
    v_mfma_f32_16x16x32_bf16 v[228:231], v[156:159], v[80:83], v[228:231]
    v_mfma_f32_16x16x32_bf16 v[248:251], v[156:159], v[84:87], v[248:251]
    v_mfma_f32_16x16x32_bf16 v[192:195], v[160:163], v[72:75], v[192:195]
    v_mfma_f32_16x16x32_bf16 v[212:215], v[160:163], v[76:79], v[212:215]
    v_mfma_f32_16x16x32_bf16 v[232:235], v[160:163], v[80:83], v[232:235]
    v_mfma_f32_16x16x32_bf16 v[252:255], v[160:163], v[84:87], v[252:255]
    s_waitcnt vmcnt(7)
    s_waitcnt lgkmcnt(0)
    ds_read_b128 v[124:127], v27 offset:0
    ds_read_b128 v[128:131], v27 offset:1024
    ds_read_b128 v[132:135], v27 offset:2048
    ds_read_b128 v[136:139], v27 offset:3072
    ds_read_b128 v[140:143], v27 offset:4096
    v_mfma_f32_16x16x32_bf16 v[176:179], v[104:107], v[88:91], v[176:179]
    v_mfma_f32_16x16x32_bf16 v[196:199], v[104:107], v[92:95], v[196:199]
    v_mfma_f32_16x16x32_bf16 v[216:219], v[104:107], v[96:99], v[216:219]
    v_mfma_f32_16x16x32_bf16 v[236:239], v[104:107], v[100:103], v[236:239]
    v_mfma_f32_16x16x32_bf16 v[180:183], v[108:111], v[88:91], v[180:183]
    v_mfma_f32_16x16x32_bf16 v[200:203], v[108:111], v[92:95], v[200:203]
    v_mfma_f32_16x16x32_bf16 v[220:223], v[108:111], v[96:99], v[220:223]
    v_mfma_f32_16x16x32_bf16 v[240:243], v[108:111], v[100:103], v[240:243]
    v_mfma_f32_16x16x32_bf16 v[184:187], v[112:115], v[88:91], v[184:187]
    v_mfma_f32_16x16x32_bf16 v[204:207], v[112:115], v[92:95], v[204:207]
    v_mfma_f32_16x16x32_bf16 v[224:227], v[112:115], v[96:99], v[224:227]
    v_mfma_f32_16x16x32_bf16 v[244:247], v[112:115], v[100:103], v[244:247]
    v_mfma_f32_16x16x32_bf16 v[188:191], v[116:119], v[88:91], v[188:191]
    v_mfma_f32_16x16x32_bf16 v[208:211], v[116:119], v[92:95], v[208:211]
    v_mfma_f32_16x16x32_bf16 v[228:231], v[116:119], v[96:99], v[228:231]
    v_mfma_f32_16x16x32_bf16 v[248:251], v[116:119], v[100:103], v[248:251]
    v_mfma_f32_16x16x32_bf16 v[192:195], v[120:123], v[88:91], v[192:195]
    v_mfma_f32_16x16x32_bf16 v[212:215], v[120:123], v[92:95], v[212:215]
    v_mfma_f32_16x16x32_bf16 v[232:235], v[120:123], v[96:99], v[232:235]
    v_mfma_f32_16x16x32_bf16 v[252:255], v[120:123], v[100:103], v[252:255]
    s_waitcnt vmcnt(3)
    s_waitcnt lgkmcnt(0)
    v_mfma_f32_16x16x32_bf16 v[176:179], v[124:127], v[40:43], v[176:179]
    v_mfma_f32_16x16x32_bf16 v[196:199], v[124:127], v[44:47], v[196:199]
    v_mfma_f32_16x16x32_bf16 v[216:219], v[124:127], v[48:51], v[216:219]
    v_mfma_f32_16x16x32_bf16 v[236:239], v[124:127], v[52:55], v[236:239]
    v_mfma_f32_16x16x32_bf16 v[180:183], v[128:131], v[40:43], v[180:183]
    v_mfma_f32_16x16x32_bf16 v[200:203], v[128:131], v[44:47], v[200:203]
    v_mfma_f32_16x16x32_bf16 v[220:223], v[128:131], v[48:51], v[220:223]
    v_mfma_f32_16x16x32_bf16 v[240:243], v[128:131], v[52:55], v[240:243]
    v_mfma_f32_16x16x32_bf16 v[184:187], v[132:135], v[40:43], v[184:187]
    v_mfma_f32_16x16x32_bf16 v[204:207], v[132:135], v[44:47], v[204:207]
    v_mfma_f32_16x16x32_bf16 v[224:227], v[132:135], v[48:51], v[224:227]
    v_mfma_f32_16x16x32_bf16 v[244:247], v[132:135], v[52:55], v[244:247]
    v_mfma_f32_16x16x32_bf16 v[188:191], v[136:139], v[40:43], v[188:191]
    v_mfma_f32_16x16x32_bf16 v[208:211], v[136:139], v[44:47], v[208:211]
    v_mfma_f32_16x16x32_bf16 v[228:231], v[136:139], v[48:51], v[228:231]
    v_mfma_f32_16x16x32_bf16 v[248:251], v[136:139], v[52:55], v[248:251]
    v_mfma_f32_16x16x32_bf16 v[192:195], v[140:143], v[40:43], v[192:195]
    v_mfma_f32_16x16x32_bf16 v[212:215], v[140:143], v[44:47], v[212:215]
    v_mfma_f32_16x16x32_bf16 v[232:235], v[140:143], v[48:51], v[232:235]
    v_mfma_f32_16x16x32_bf16 v[252:255], v[140:143], v[52:55], v[252:255]
    ds_write_b128 v25, v[176:179] offset:0
    ds_write_b128 v25, v[196:199] offset:5376
    ds_write_b128 v25, v[216:219] offset:10752
    ds_write_b128 v25, v[236:239] offset:16128
    ds_write_b128 v25, v[180:183] offset:64
    ds_write_b128 v25, v[200:203] offset:5440
    ds_write_b128 v25, v[220:223] offset:10816
    ds_write_b128 v25, v[240:243] offset:16192
    ds_write_b128 v25, v[184:187] offset:128
    ds_write_b128 v25, v[204:207] offset:5504
    ds_write_b128 v25, v[224:227] offset:10880
    ds_write_b128 v25, v[244:247] offset:16256
    ds_write_b128 v25, v[188:191] offset:192
    ds_write_b128 v25, v[208:211] offset:5568
    ds_write_b128 v25, v[228:231] offset:10944
    ds_write_b128 v25, v[248:251] offset:16320
    ds_write_b128 v25, v[192:195] offset:256
    ds_write_b128 v25, v[212:215] offset:5632
    ds_write_b128 v25, v[232:235] offset:11008
    ds_write_b128 v25, v[252:255] offset:16384
    v_add_u32 v160, 79872, v10
    v_add_u32 v161, 79872, v11
    v_add_u32 v162, 79872, v12
    s_waitcnt lgkmcnt(0)
    s_barrier
    ds_read_b128 v[40:43], v10 offset:0
    ds_read_b128 v[44:47], v10 offset:16
    ds_read_b128 v[48:51], v10 offset:39936
    ds_read_b128 v[52:55], v10 offset:39952
    ds_read_b128 v[56:59], v160 offset:0
    ds_read_b128 v[60:63], v160 offset:16
    ds_read_b128 v[64:67], v160 offset:39936
    ds_read_b128 v[68:71], v160 offset:39952
    s_waitcnt vmcnt(0)
    ds_read_b128 v[72:75], v11 offset:0
    ds_read_b128 v[76:79], v11 offset:16
    ds_read_b128 v[80:83], v11 offset:39936
    ds_read_b128 v[84:87], v11 offset:39952
    ds_read_b128 v[88:91], v161 offset:0
    ds_read_b128 v[92:95], v161 offset:16
    ds_read_b128 v[96:99], v161 offset:39936
    ds_read_b128 v[100:103], v161 offset:39952
    v_lshlrev_b32 v144, 16, v32
    v_and_b32 v145, 0xffff0000, v32
    v_lshlrev_b32 v146, 16, v33
    v_and_b32 v147, 0xffff0000, v33
    v_lshlrev_b32 v148, 16, v34
    v_and_b32 v149, 0xffff0000, v34
    v_lshlrev_b32 v150, 16, v35
    v_and_b32 v151, 0xffff0000, v35
    s_waitcnt lgkmcnt(8)
    v_pk_add_f32 v[40:41], v[40:41], v[48:49]
    v_pk_add_f32 v[56:57], v[56:57], v[64:65]
    v_pk_add_f32 v[42:43], v[42:43], v[50:51]
    v_pk_add_f32 v[58:59], v[58:59], v[66:67]
    v_pk_add_f32 v[44:45], v[44:45], v[52:53]
    v_pk_add_f32 v[60:61], v[60:61], v[68:69]
    v_pk_add_f32 v[46:47], v[46:47], v[54:55]
    v_pk_add_f32 v[62:63], v[62:63], v[70:71]
    v_pk_add_f32 v[40:41], v[40:41], v[56:57]
    v_pk_add_f32 v[42:43], v[42:43], v[58:59]
    v_pk_add_f32 v[44:45], v[44:45], v[60:61]
    v_pk_add_f32 v[46:47], v[46:47], v[62:63]
    v_pk_fma_f32 v[40:41], v[40:41], v[168:169], v[144:145] op_sel_hi:[1,0,1]
    v_pk_fma_f32 v[42:43], v[42:43], v[168:169], v[146:147] op_sel_hi:[1,0,1]
    v_pk_fma_f32 v[44:45], v[44:45], v[168:169], v[148:149] op_sel_hi:[1,0,1]
    v_pk_fma_f32 v[46:47], v[46:47], v[168:169], v[150:151] op_sel_hi:[1,0,1]
    v_cvt_pk_bf16_f32 v40, v40, v41
    v_cvt_pk_bf16_f32 v41, v42, v43
    v_cvt_pk_bf16_f32 v42, v44, v45
    v_cvt_pk_bf16_f32 v43, v46, v47
    buffer_store_dwordx4 v[40:43], v13, s[36:39], s66 offen
    ds_read_b128 v[104:107], v12 offset:0
    ds_read_b128 v[108:111], v12 offset:16
    ds_read_b128 v[112:115], v12 offset:39936
    ds_read_b128 v[116:119], v12 offset:39952
    ds_read_b128 v[120:123], v162 offset:0
    ds_read_b128 v[124:127], v162 offset:16
    ds_read_b128 v[128:131], v162 offset:39936
    ds_read_b128 v[132:135], v162 offset:39952
    v_lshlrev_b32 v144, 16, v36
    v_and_b32 v145, 0xffff0000, v36
    v_lshlrev_b32 v146, 16, v37
    v_and_b32 v147, 0xffff0000, v37
    v_lshlrev_b32 v148, 16, v38
    v_and_b32 v149, 0xffff0000, v38
    v_lshlrev_b32 v150, 16, v39
    v_and_b32 v151, 0xffff0000, v39
    s_waitcnt lgkmcnt(8)
    v_pk_add_f32 v[72:73], v[72:73], v[80:81]
    v_pk_add_f32 v[88:89], v[88:89], v[96:97]
    v_pk_add_f32 v[74:75], v[74:75], v[82:83]
    v_pk_add_f32 v[90:91], v[90:91], v[98:99]
    v_pk_add_f32 v[76:77], v[76:77], v[84:85]
    v_pk_add_f32 v[92:93], v[92:93], v[100:101]
    v_pk_add_f32 v[78:79], v[78:79], v[86:87]
    v_pk_add_f32 v[94:95], v[94:95], v[102:103]
    v_pk_add_f32 v[72:73], v[72:73], v[88:89]
    v_pk_add_f32 v[74:75], v[74:75], v[90:91]
    v_pk_add_f32 v[76:77], v[76:77], v[92:93]
    v_pk_add_f32 v[78:79], v[78:79], v[94:95]
    v_pk_fma_f32 v[72:73], v[72:73], v[170:171], v[144:145] op_sel_hi:[1,0,1]
    v_pk_fma_f32 v[74:75], v[74:75], v[170:171], v[146:147] op_sel_hi:[1,0,1]
    v_pk_fma_f32 v[76:77], v[76:77], v[170:171], v[148:149] op_sel_hi:[1,0,1]
    v_pk_fma_f32 v[78:79], v[78:79], v[170:171], v[150:151] op_sel_hi:[1,0,1]
    v_cvt_pk_bf16_f32 v72, v72, v73
    v_cvt_pk_bf16_f32 v73, v74, v75
    v_cvt_pk_bf16_f32 v74, v76, v77
    v_cvt_pk_bf16_f32 v75, v78, v79
    buffer_store_dwordx4 v[72:75], v14, s[36:39], s66 offen
    v_lshlrev_b32 v144, 16, v20
    v_and_b32 v145, 0xffff0000, v20
    v_lshlrev_b32 v146, 16, v21
    v_and_b32 v147, 0xffff0000, v21
    v_lshlrev_b32 v148, 16, v22
    v_and_b32 v149, 0xffff0000, v22
    v_lshlrev_b32 v150, 16, v23
    v_and_b32 v151, 0xffff0000, v23
    s_waitcnt lgkmcnt(0)
    v_pk_add_f32 v[104:105], v[104:105], v[112:113]
    v_pk_add_f32 v[120:121], v[120:121], v[128:129]
    v_pk_add_f32 v[106:107], v[106:107], v[114:115]
    v_pk_add_f32 v[122:123], v[122:123], v[130:131]
    v_pk_add_f32 v[108:109], v[108:109], v[116:117]
    v_pk_add_f32 v[124:125], v[124:125], v[132:133]
    v_pk_add_f32 v[110:111], v[110:111], v[118:119]
    v_pk_add_f32 v[126:127], v[126:127], v[134:135]
    v_pk_add_f32 v[104:105], v[104:105], v[120:121]
    v_pk_add_f32 v[106:107], v[106:107], v[122:123]
    v_pk_add_f32 v[108:109], v[108:109], v[124:125]
    v_pk_add_f32 v[110:111], v[110:111], v[126:127]
    v_pk_fma_f32 v[104:105], v[104:105], v[172:173], v[144:145] op_sel_hi:[1,0,1]
    v_pk_fma_f32 v[106:107], v[106:107], v[172:173], v[146:147] op_sel_hi:[1,0,1]
    v_pk_fma_f32 v[108:109], v[108:109], v[172:173], v[148:149] op_sel_hi:[1,0,1]
    v_pk_fma_f32 v[110:111], v[110:111], v[172:173], v[150:151] op_sel_hi:[1,0,1]
    v_cvt_pk_bf16_f32 v104, v104, v105
    v_cvt_pk_bf16_f32 v105, v106, v107
    v_cvt_pk_bf16_f32 v106, v108, v109
    v_cvt_pk_bf16_f32 v107, v110, v111
    buffer_store_dwordx4 v[104:107], v15, s[36:39], s66 offen
    s_endpgm
L_cons:
    s_waitcnt lgkmcnt(0)
    s_lshr_b32 s60, s2, 3
    s_bfe_u32 s61, s2, 0x20001
    s_mul_i32 s61, s61, 160
    s_mul_i32 s62, s60, 5
    s_add_u32 s61, s61, s62
    s_cmp_eq_u32 s3, 1
    s_cbranch_scc1 L_tp_w1
    s_cmp_eq_u32 s3, 2
    s_cbranch_scc1 L_tp_x
    s_cmp_eq_u32 s3, 0
    s_cbranch_scc0 L_tp_done
    s_mov_b32 s24, s6
    s_and_b32 s25, s7, 0xffff
    s_mov_b32 s26, 2457600
    s_mov_b32 s27, 0x20000
    v_lshrrev_b32 v4, 4, v0
    v_and_b32 v5, 15, v0
    v_min_u32 v5, 14, v5
    v_mul_u32_u24 v6, 52, v5
    v_lshrrev_b32 v6, 8, v6
    v_mul_u32_u24 v6, 5, v6
    v_add_u32 v5, v5, v6
    v_mul_u32_u24 v4, 3840, v4
    v_lshl_add_u32 v4, v5, 7, v4
    s_mul_i32 s61, s61, 3840
    s_mul_i32 s62, s49, 640
    s_add_u32 s61, s61, s62
    buffer_load_dword v250, v4, s[24:27], s61 offen
    s_add_u32 s61, s61, 15360
    s_mov_b64 exec, 0xffff
    buffer_load_dword v251, v4, s[24:27], s61 offen
    s_mov_b64 exec, -1
    s_branch L_tp_done
L_tp_w1:
    s_mov_b32 s28, s8
    s_and_b32 s29, s9, 0xffff
    s_mov_b32 s30, 1966080
    s_mov_b32 s31, 0x20000
    v_min_u32 v5, 59, v0
    v_mul_u32_u24 v4, 43, v5
    v_lshrrev_b32 v4, 9, v4
    v_mul_u32_u24 v6, 12, v4
    v_sub_u32 v5, v5, v6
    v_mul_u32_u24 v4, 3072, v4
    v_lshl_add_u32 v4, v5, 7, v4
    s_mul_i32 s61, s61, 3072
    s_mul_i32 s62, s49, 1536
    s_add_u32 s61, s61, s62
    buffer_load_dword v250, v4, s[28:31], s61 offen
    s_branch L_tp_done
L_tp_x:
    s_mov_b32 s20, s4
    s_and_b32 s21, s5, 0xffff
    s_mov_b32 s22, 2621440
    s_mov_b32 s23, 0x20000
    v_lshlrev_b32 v4, 7, v0
    s_and_b32 s61, s2, 7
    s_lshl_b32 s61, s61, 5
    s_add_u32 s61, s61, s60
    s_mul_i32 s61, s61, 10240
    buffer_load_dword v250, v4, s[20:23], s61 offen
    s_add_u32 s61, s61, 8192
    s_mov_b64 exec, 0xffff
    buffer_load_dword v251, v4, s[20:23], s61 offen
    s_mov_b64 exec, -1
L_tp_done:
    s_barrier
    s_setprio 2
    v_and_b32 v1, 31, v0
    v_lshrrev_b32 v2, 5, v0
    v_bfe_u32 v3, v0, 1, 3
    v_xor_b32 v3, v3, v2
    v_lshlrev_b32 v3, 4, v3
    v_lshl_add_u32 v3, v1, 7, v3
    s_mul_i32 s68, s3, 39936
    v_add_u32 v10, s68, v3
    v_xor_b32 v11, 32, v10
    v_xor_b32 v12, 64, v10
    v_xor_b32 v13, 0x60, v10
    v_bfe_u32 v7, v0, 2, 2
    v_lshl_add_u32 v8, v2, 3, v7
    v_bfe_u32 v9, v0, 4, 1
    v_and_b32 v3, 3, v0
    v_lshlrev_b32 v3, 3, v3
    v_lshl_add_u32 v3, v9, 5, v3
    s_cmp_eq_u32 s46, 0
    s_movk_i32 s60, 192
    s_cselect_b32 s60, 320, s60
    v_mul_u32_u24 v16, s60, v8
    v_add_u32 v16, v16, v3
    v_lshrrev_b32 v7, 1, v7
    v_lshl_add_u32 v3, v7, 6, v3
    v_lshl_add_u32 v14, v8, 7, v3
    v_xor_b32 v15, 64, v14
    s_mov_b32 s69, 0x3f803f80
    s_mov_b32 s70, 0
    s_mov_b32 s71, 13312
    s_mov_b32 s72, 0
    v_mov_b32 v26, 162944
    v_mov_b64 v[96:97], 0
    v_mov_b64 v[98:99], 0
    v_mov_b64 v[100:101], 0
    v_mov_b64 v[102:103], 0
    v_mov_b64 v[104:105], 0
    v_mov_b64 v[106:107], 0
    v_mov_b64 v[108:109], 0
    v_mov_b64 v[110:111], 0
    v_mov_b64 v[112:113], 0
    v_mov_b64 v[114:115], 0
    v_mov_b64 v[116:117], 0
    v_mov_b64 v[118:119], 0
    v_mov_b64 v[120:121], 0
    v_mov_b64 v[122:123], 0
    v_mov_b64 v[124:125], 0
    v_mov_b64 v[126:127], 0
    v_mov_b64 v[128:129], 0
    v_mov_b64 v[130:131], 0
    v_mov_b64 v[132:133], 0
    v_mov_b64 v[134:135], 0
    v_mov_b64 v[136:137], 0
    v_mov_b64 v[138:139], 0
    v_mov_b64 v[140:141], 0
    v_mov_b64 v[142:143], 0
    v_mov_b64 v[144:145], 0
    v_mov_b64 v[146:147], 0
    v_mov_b64 v[148:149], 0
    v_mov_b64 v[150:151], 0
    v_mov_b64 v[152:153], 0
    v_mov_b64 v[154:155], 0
    v_mov_b64 v[156:157], 0
    v_mov_b64 v[158:159], 0
    v_mov_b64 v[160:161], 0
    v_mov_b64 v[162:163], 0
    v_mov_b64 v[164:165], 0
    v_mov_b64 v[166:167], 0
    v_mov_b64 v[168:169], 0
    v_mov_b64 v[170:171], 0
    v_mov_b64 v[172:173], 0
    v_mov_b64 v[174:175], 0
    s_lshl_b32 s60, s3, 8
    s_add_u32 s60, s60, 160896
    v_lshlrev_b32 v25, 3, v1
    v_add_u32 v25, s60, v25
    v_lshlrev_b32 v21, 4, v2
    v_add_u32 v21, 159744, v21
    v_lshlrev_b32 v24, 10, v9
    v_lshl_add_u32 v24, v2, 8, v24
    v_and_b32 v5, 15, v0
    v_lshl_add_u32 v24, v5, 4, v24
    s_lshr_b32 s60, s3, 1
    s_lshl_b32 s61, s44, 1
    s_add_u32 s60, s60, s61
    s_mul_i32 s60, s60, 278528
    s_and_b32 s61, s3, 1
    s_lshl_b32 s61, s61, 11
    s_add_u32 s65, s60, s61
    s_mul_i32 s60, s45, 24576
    s_add_u32 s66, s65, s60
    s_mov_b32 s52, 0x3fb8aa3b
    s_mov_b32 s53, 0x3fb8aa3b
    s_mov_b32 s64, 0x358637bd
    s_mov_b32 s74, 0x358637bd
    s_mov_b32 s75, 0x358637bd
    s_lshl_b32 s60, s3, 6
    v_add_u32 v27, s60, v0
    s_waitcnt lgkmcnt(0)
    s_mov_b32 s32, s14
    s_and_b32 s33, s15, 0xffff
    s_mov_b32 s34, 14155776
    s_mov_b32 s35, 0x20000
    s_cmp_eq_u32 s46, 0
    s_cbranch_scc1 L_coA
    v_mov_b64 v[176:177], 0
    v_mov_b64 v[178:179], 0
    v_mov_b64 v[180:181], 0
    v_mov_b64 v[182:183], 0
    v_mov_b64 v[184:185], 0
    v_mov_b64 v[186:187], 0
    v_mov_b64 v[188:189], 0
    v_mov_b64 v[190:191], 0
    v_mov_b64 v[192:193], 0
    v_mov_b64 v[194:195], 0
    v_mov_b64 v[196:197], 0
    v_mov_b64 v[198:199], 0
    v_mov_b64 v[200:201], 0
    v_mov_b64 v[202:203], 0
    v_mov_b64 v[204:205], 0
    v_mov_b64 v[206:207], 0
    v_mov_b64 v[208:209], 0
    v_mov_b64 v[210:211], 0
    v_mov_b64 v[212:213], 0
    v_mov_b64 v[214:215], 0
    v_mov_b64 v[216:217], 0
    v_mov_b64 v[218:219], 0
    v_mov_b64 v[220:221], 0
    v_mov_b64 v[222:223], 0
    v_mov_b64 v[224:225], 0
    v_mov_b64 v[226:227], 0
    v_mov_b64 v[228:229], 0
    v_mov_b64 v[230:231], 0
    v_mov_b64 v[232:233], 0
    v_mov_b64 v[234:235], 0
    v_mov_b64 v[236:237], 0
    v_mov_b64 v[238:239], 0
    v_mul_u32_u24 v4, 205, v27
    v_lshrrev_b32 v4, 10, v4
    v_mul_u32_u24 v5, 5, v4
    v_sub_u32 v5, v27, v5
    v_mul_u32_u24 v6, 205, v4
    v_lshrrev_b32 v6, 12, v6
    v_subrev_u32 v7, 80, v4
    v_cmp_lt_u32 vcc, 79, v4
    s_nop 1
    v_cndmask_b32 v6, v6, v7, vcc
    v_mul_u32_u24 v6, 5, v6
    v_add_u32 v6, v6, v5
    v_lshrrev_b32 v7, 2, v6
    v_lshlrev_b32 v7, 5, v7
    v_and_b32 v8, 1, v6
    v_lshl_add_u32 v7, v8, 4, v7
    v_bfe_u32 v8, v6, 1, 1
    v_lshl_add_u32 v7, v8, 3, v7
    v_lshrrev_b32 v8, 5, v4
    v_mul_u32_u24 v8, 34816, v8
    v_mul_u32_u24 v4, 160, v4
    v_add3_u32 v4, v4, v7, v8
    v_add_u32 v240, 5120, v4
    v_add_u32 v244, 256, v27
    v_mul_u32_u24 v4, 205, v244
    v_lshrrev_b32 v4, 10, v4
    v_mul_u32_u24 v5, 5, v4
    v_sub_u32 v5, v244, v5
    v_mul_u32_u24 v6, 205, v4
    v_lshrrev_b32 v6, 12, v6
    v_subrev_u32 v7, 80, v4
    v_cmp_lt_u32 vcc, 79, v4
    s_nop 1
    v_cndmask_b32 v6, v6, v7, vcc
    v_mul_u32_u24 v6, 5, v6
    v_add_u32 v6, v6, v5
    v_lshrrev_b32 v7, 2, v6
    v_lshlrev_b32 v7, 5, v7
    v_and_b32 v8, 1, v6
    v_lshl_add_u32 v7, v8, 4, v7
    v_bfe_u32 v8, v6, 1, 1
    v_lshl_add_u32 v7, v8, 3, v7
    v_lshrrev_b32 v8, 5, v4
    v_mul_u32_u24 v8, 34816, v8
    v_mul_u32_u24 v4, 160, v4
    v_add3_u32 v4, v4, v7, v8
    v_add_u32 v241, 5120, v4
    v_lshlrev_b32 v245, 4, v27
    v_add_u32 v246, 4096, v245
    v_mul_u32_u24 v4, 160, v1
    v_lshl_add_u32 v4, v2, 4, v4
    v_add_u32 v242, 5120, v4
    v_add_u32 v243, 84992, v4
    v_cmp_lt_u32 s[76:77], 31, v0
    s_lshl_b32 s59, s44, 3
    s_add_u32 s59, s59, s45
    s_lshl_b32 s59, s59, 7
    s_add_u32 s59, s59, 14057472
    v_and_b32 v247, 15, v0
    v_lshlrev_b32 v247, 2, v247
    s_add_u32 s60, s70, 0
    v_add_u32 v18, s60, v14
    v_add_u32 v19, s60, v15
    v_add_u32 v20, s60, v16
    v_add_u32 v17, s70, v10
    s_barrier
    ds_read_b128 v[36:39], v17
    ds_read_b64_tr_b16 v[44:45], v18 offset:4096
    ds_read_b64_tr_b16 v[46:47], v18 offset:4608
    ds_read_b64_tr_b16 v[48:49], v19 offset:4096
    ds_read_b64_tr_b16 v[50:51], v19 offset:4608
    ds_read_b64_tr_b16 v[52:53], v18 offset:6144
    ds_read_b64_tr_b16 v[54:55], v18 offset:6656
    ds_read_b64_tr_b16 v[56:57], v19 offset:6144
    ds_read_b64_tr_b16 v[58:59], v19 offset:6656
    ds_read_b64_tr_b16 v[60:61], v18 offset:8192
    ds_read_b64_tr_b16 v[62:63], v18 offset:8704
    ds_read_b64_tr_b16 v[64:65], v19 offset:8192
    ds_read_b64_tr_b16 v[66:67], v19 offset:8704
    ds_read_b64_tr_b16 v[68:69], v20 offset:10240
    ds_read_b64_tr_b16 v[70:71], v20 offset:11008
    ds_read_b64_tr_b16 v[72:73], v20 offset:10304
    ds_read_b64_tr_b16 v[74:75], v20 offset:11072
L_main_B:
    s_waitcnt lgkmcnt(12)
    v_mfma_f32_32x32x16_bf16 v[96:111], v[44:47], v[36:39], v[96:111]
    ds_read_b64_tr_b16 v[76:77], v20 offset:10368
    ds_read_b64_tr_b16 v[78:79], v20 offset:11136
    s_add_u32 s60, s70, 39936
    v_add_u32 v18, s60, v14
    v_add_u32 v19, s60, v15
    v_add_u32 v20, s60, v16
    v_add_u32 v17, s70, v11
    ds_read_b128 v[40:43], v17
    v_mfma_f32_32x32x16_bf16 v[112:127], v[48:51], v[36:39], v[112:127]
    ds_read_b64_tr_b16 v[44:45], v18 offset:4096
    ds_read_b64_tr_b16 v[46:47], v18 offset:4608
    s_waitcnt lgkmcnt(13)
    v_mfma_f32_32x32x16_bf16 v[128:143], v[52:55], v[36:39], v[128:143]
    ds_read_b64_tr_b16 v[48:49], v19 offset:4096
    ds_read_b64_tr_b16 v[50:51], v19 offset:4608
    v_mfma_f32_32x32x16_bf16 v[144:159], v[56:59], v[36:39], v[144:159]
    ds_read_b64_tr_b16 v[52:53], v18 offset:6144
    ds_read_b64_tr_b16 v[54:55], v18 offset:6656
    s_waitcnt lgkmcnt(13)
    v_mfma_f32_32x32x16_bf16 v[160:175], v[60:63], v[36:39], v[160:175]
    ds_read_b64_tr_b16 v[56:57], v19 offset:6144
    ds_read_b64_tr_b16 v[58:59], v19 offset:6656
    v_mfma_f32_32x32x16_bf16 v[176:191], v[64:67], v[36:39], v[176:191]
    ds_read_b64_tr_b16 v[60:61], v18 offset:8192
    ds_read_b64_tr_b16 v[62:63], v18 offset:8704
    s_waitcnt lgkmcnt(13)
    v_mfma_f32_32x32x16_bf16 v[192:207], v[68:71], v[36:39], v[192:207]
    ds_read_b64_tr_b16 v[64:65], v19 offset:8192
    ds_read_b64_tr_b16 v[66:67], v19 offset:8704
    v_mfma_f32_32x32x16_bf16 v[208:223], v[72:75], v[36:39], v[208:223]
    ds_read_b64_tr_b16 v[68:69], v20 offset:10240
    ds_read_b64_tr_b16 v[70:71], v20 offset:11008
    s_waitcnt lgkmcnt(15)
    v_mfma_f32_32x32x16_bf16 v[224:239], v[76:79], v[36:39], v[224:239]
    ds_read_b64_tr_b16 v[72:73], v20 offset:10304
    ds_read_b64_tr_b16 v[74:75], v20 offset:11072
    s_waitcnt lgkmcnt(12)
    v_mfma_f32_32x32x16_bf16 v[96:111], v[44:47], v[40:43], v[96:111]
    ds_read_b64_tr_b16 v[76:77], v20 offset:10368
    ds_read_b64_tr_b16 v[78:79], v20 offset:11136
    s_add_u32 s60, s70, 79872
    v_add_u32 v18, s60, v14
    v_add_u32 v19, s60, v15
    v_add_u32 v20, s60, v16
    v_add_u32 v17, s70, v12
    ds_read_b128 v[36:39], v17
    v_mfma_f32_32x32x16_bf16 v[112:127], v[48:51], v[40:43], v[112:127]
    ds_read_b64_tr_b16 v[44:45], v18 offset:4096
    ds_read_b64_tr_b16 v[46:47], v18 offset:4608
    s_waitcnt lgkmcnt(13)
    v_mfma_f32_32x32x16_bf16 v[128:143], v[52:55], v[40:43], v[128:143]
    ds_read_b64_tr_b16 v[48:49], v19 offset:4096
    ds_read_b64_tr_b16 v[50:51], v19 offset:4608
    v_mfma_f32_32x32x16_bf16 v[144:159], v[56:59], v[40:43], v[144:159]
    ds_read_b64_tr_b16 v[52:53], v18 offset:6144
    ds_read_b64_tr_b16 v[54:55], v18 offset:6656
    s_waitcnt lgkmcnt(13)
    v_mfma_f32_32x32x16_bf16 v[160:175], v[60:63], v[40:43], v[160:175]
    ds_read_b64_tr_b16 v[56:57], v19 offset:6144
    ds_read_b64_tr_b16 v[58:59], v19 offset:6656
    v_mfma_f32_32x32x16_bf16 v[176:191], v[64:67], v[40:43], v[176:191]
    ds_read_b64_tr_b16 v[60:61], v18 offset:8192
    ds_read_b64_tr_b16 v[62:63], v18 offset:8704
    s_waitcnt lgkmcnt(13)
    v_mfma_f32_32x32x16_bf16 v[192:207], v[68:71], v[40:43], v[192:207]
    ds_read_b64_tr_b16 v[64:65], v19 offset:8192
    ds_read_b64_tr_b16 v[66:67], v19 offset:8704
    v_mfma_f32_32x32x16_bf16 v[208:223], v[72:75], v[40:43], v[208:223]
    ds_read_b64_tr_b16 v[68:69], v20 offset:10240
    ds_read_b64_tr_b16 v[70:71], v20 offset:11008
    s_waitcnt lgkmcnt(15)
    v_mfma_f32_32x32x16_bf16 v[224:239], v[76:79], v[40:43], v[224:239]
    ds_read_b64_tr_b16 v[72:73], v20 offset:10304
    ds_read_b64_tr_b16 v[74:75], v20 offset:11072
    s_waitcnt lgkmcnt(12)
    v_mfma_f32_32x32x16_bf16 v[96:111], v[44:47], v[36:39], v[96:111]
    ds_read_b64_tr_b16 v[76:77], v20 offset:10368
    ds_read_b64_tr_b16 v[78:79], v20 offset:11136
    s_add_u32 s60, s70, 119808
    v_add_u32 v18, s60, v14
    v_add_u32 v19, s60, v15
    v_add_u32 v20, s60, v16
    v_add_u32 v17, s70, v13
    ds_read_b128 v[40:43], v17
    v_mfma_f32_32x32x16_bf16 v[112:127], v[48:51], v[36:39], v[112:127]
    ds_read_b64_tr_b16 v[44:45], v18 offset:4096
    ds_read_b64_tr_b16 v[46:47], v18 offset:4608
    s_waitcnt lgkmcnt(13)
    v_mfma_f32_32x32x16_bf16 v[128:143], v[52:55], v[36:39], v[128:143]
    ds_read_b64_tr_b16 v[48:49], v19 offset:4096
    ds_read_b64_tr_b16 v[50:51], v19 offset:4608
    v_mfma_f32_32x32x16_bf16 v[144:159], v[56:59], v[36:39], v[144:159]
    ds_read_b64_tr_b16 v[52:53], v18 offset:6144
    ds_read_b64_tr_b16 v[54:55], v18 offset:6656
    s_waitcnt lgkmcnt(13)
    v_mfma_f32_32x32x16_bf16 v[160:175], v[60:63], v[36:39], v[160:175]
    ds_read_b64_tr_b16 v[56:57], v19 offset:6144
    ds_read_b64_tr_b16 v[58:59], v19 offset:6656
    v_mfma_f32_32x32x16_bf16 v[176:191], v[64:67], v[36:39], v[176:191]
    ds_read_b64_tr_b16 v[60:61], v18 offset:8192
    ds_read_b64_tr_b16 v[62:63], v18 offset:8704
    s_waitcnt lgkmcnt(13)
    v_mfma_f32_32x32x16_bf16 v[192:207], v[68:71], v[36:39], v[192:207]
    ds_read_b64_tr_b16 v[64:65], v19 offset:8192
    ds_read_b64_tr_b16 v[66:67], v19 offset:8704
    v_mfma_f32_32x32x16_bf16 v[208:223], v[72:75], v[36:39], v[208:223]
    ds_read_b64_tr_b16 v[68:69], v20 offset:10240
    ds_read_b64_tr_b16 v[70:71], v20 offset:11008
    s_waitcnt lgkmcnt(15)
    v_mfma_f32_32x32x16_bf16 v[224:239], v[76:79], v[36:39], v[224:239]
    ds_read_b64_tr_b16 v[72:73], v20 offset:10304
    ds_read_b64_tr_b16 v[74:75], v20 offset:11072
    s_waitcnt lgkmcnt(14)
    v_mfma_f32_32x32x16_bf16 v[96:111], v[44:47], v[40:43], v[96:111]
    ds_read_b64_tr_b16 v[76:77], v20 offset:10368
    ds_read_b64_tr_b16 v[78:79], v20 offset:11136
    s_add_u32 s60, s71, 0
    v_add_u32 v18, s60, v14
    v_add_u32 v19, s60, v15
    v_add_u32 v20, s60, v16
    v_add_u32 v17, s71, v10
    s_waitcnt lgkmcnt(14)
    v_mfma_f32_32x32x16_bf16 v[112:127], v[48:51], v[40:43], v[112:127]
    s_waitcnt lgkmcnt(12)
    v_mfma_f32_32x32x16_bf16 v[128:143], v[52:55], v[40:43], v[128:143]
    s_waitcnt lgkmcnt(0)
    s_barrier
    s_cmp_eq_u32 s72, 9
    s_cbranch_scc1 L_last_B
    ds_read_b128 v[36:39], v17
    ds_read_b64_tr_b16 v[44:45], v18 offset:4096
    ds_read_b64_tr_b16 v[46:47], v18 offset:4608
    ds_read_b64_tr_b16 v[48:49], v19 offset:4096
    ds_read_b64_tr_b16 v[50:51], v19 offset:4608
    v_mfma_f32_32x32x16_bf16 v[144:159], v[56:59], v[40:43], v[144:159]
    ds_read_b64_tr_b16 v[52:53], v18 offset:6144
    ds_read_b64_tr_b16 v[54:55], v18 offset:6656
    v_mfma_f32_32x32x16_bf16 v[160:175], v[60:63], v[40:43], v[160:175]
    ds_read_b64_tr_b16 v[56:57], v19 offset:6144
    ds_read_b64_tr_b16 v[58:59], v19 offset:6656
    v_mfma_f32_32x32x16_bf16 v[176:191], v[64:67], v[40:43], v[176:191]
    ds_read_b64_tr_b16 v[60:61], v18 offset:8192
    ds_read_b64_tr_b16 v[62:63], v18 offset:8704
    v_mfma_f32_32x32x16_bf16 v[192:207], v[68:71], v[40:43], v[192:207]
    ds_read_b64_tr_b16 v[64:65], v19 offset:8192
    ds_read_b64_tr_b16 v[66:67], v19 offset:8704
    v_mfma_f32_32x32x16_bf16 v[208:223], v[72:75], v[40:43], v[208:223]
    ds_read_b64_tr_b16 v[68:69], v20 offset:10240
    ds_read_b64_tr_b16 v[70:71], v20 offset:11008
    v_mfma_f32_32x32x16_bf16 v[224:239], v[76:79], v[40:43], v[224:239]
    ds_read_b64_tr_b16 v[72:73], v20 offset:10304
    ds_read_b64_tr_b16 v[74:75], v20 offset:11072
    s_mov_b32 s70, s71
    s_add_u32 s71, s71, 13312
    s_cmp_ge_u32 s71, 39936
    s_cselect_b32 s71, 0, s71
    s_add_u32 s72, s72, 1
    s_branch L_main_B
L_last_B:
    ds_read_b64 v[22:23], v25
    ds_read_b128 v[80:83], v21 offset:0
    ds_read_b128 v[84:87], v21 offset:32
    ds_read_b128 v[88:91], v21 offset:64
    ds_read_b128 v[92:95], v21 offset:96
    v_mfma_f32_32x32x16_bf16 v[144:159], v[56:59], v[40:43], v[144:159]
    v_mfma_f32_32x32x16_bf16 v[160:175], v[60:63], v[40:43], v[160:175]
    v_mfma_f32_32x32x16_bf16 v[176:191], v[64:67], v[40:43], v[176:191]
    v_mfma_f32_32x32x16_bf16 v[192:207], v[68:71], v[40:43], v[192:207]
    v_mfma_f32_32x32x16_bf16 v[208:223], v[72:75], v[40:43], v[208:223]
    v_mfma_f32_32x32x16_bf16 v[224:239], v[76:79], v[40:43], v[224:239]
    ds_read_b128 v[44:47], v21 offset:128
    ds_read_b128 v[48:51], v21 offset:160
    ds_read_b128 v[52:55], v21 offset:192
    ds_read_b128 v[56:59], v21 offset:224
    s_waitcnt lgkmcnt(4)
    v_pk_fma_f32 v[96:97], v[80:81], v[22:23], v[96:97] op_sel:[0,1,0] op_sel_hi:[1,1,1] neg_lo:[1,0,0] neg_hi:[1,0,0]
    v_pk_fma_f32 v[98:99], v[82:83], v[22:23], v[98:99] op_sel:[0,1,0] op_sel_hi:[1,1,1] neg_lo:[1,0,0] neg_hi:[1,0,0]
    v_pk_fma_f32 v[100:101], v[84:85], v[22:23], v[100:101] op_sel:[0,1,0] op_sel_hi:[1,1,1] neg_lo:[1,0,0] neg_hi:[1,0,0]
    v_pk_fma_f32 v[102:103], v[86:87], v[22:23], v[102:103] op_sel:[0,1,0] op_sel_hi:[1,1,1] neg_lo:[1,0,0] neg_hi:[1,0,0]
    v_pk_fma_f32 v[104:105], v[88:89], v[22:23], v[104:105] op_sel:[0,1,0] op_sel_hi:[1,1,1] neg_lo:[1,0,0] neg_hi:[1,0,0]
    v_pk_fma_f32 v[106:107], v[90:91], v[22:23], v[106:107] op_sel:[0,1,0] op_sel_hi:[1,1,1] neg_lo:[1,0,0] neg_hi:[1,0,0]
    v_pk_fma_f32 v[108:109], v[92:93], v[22:23], v[108:109] op_sel:[0,1,0] op_sel_hi:[1,1,1] neg_lo:[1,0,0] neg_hi:[1,0,0]
    v_pk_fma_f32 v[110:111], v[94:95], v[22:23], v[110:111] op_sel:[0,1,0] op_sel_hi:[1,1,1] neg_lo:[1,0,0] neg_hi:[1,0,0]
    v_cvt_pk_bf16_f32 v96, v96, v97
    v_cvt_pk_bf16_f32 v97, v98, v99
    v_cvt_pk_bf16_f32 v98, v100, v101
    v_cvt_pk_bf16_f32 v99, v102, v103
    v_cvt_pk_bf16_f32 v100, v104, v105
    v_cvt_pk_bf16_f32 v101, v106, v107
    v_cvt_pk_bf16_f32 v102, v108, v109
    v_cvt_pk_bf16_f32 v103, v110, v111
    v_pk_max_i16 v96, v96, 0
    v_pk_max_i16 v97, v97, 0
    v_pk_max_i16 v98, v98, 0
    v_pk_max_i16 v99, v99, 0
    v_pk_max_i16 v100, v100, 0
    v_pk_max_i16 v101, v101, 0
    v_pk_max_i16 v102, v102, 0
    v_pk_max_i16 v103, v103, 0
    s_add_u32 s67, s66, 0
    buffer_store_dwordx4 v[96:99], v24, s[32:35], s67 offen sc1
    buffer_store_dwordx4 v[100:103], v24, s[32:35], s67 offen offset:512 sc1
    ds_read_b128 v[80:83], v21 offset:256
    ds_read_b128 v[84:87], v21 offset:288
    ds_read_b128 v[88:91], v21 offset:320
    ds_read_b128 v[92:95], v21 offset:352
    s_waitcnt lgkmcnt(4)
    v_pk_fma_f32 v[112:113], v[44:45], v[22:23], v[112:113] op_sel:[0,1,0] op_sel_hi:[1,1,1] neg_lo:[1,0,0] neg_hi:[1,0,0]
    v_pk_fma_f32 v[114:115], v[46:47], v[22:23], v[114:115] op_sel:[0,1,0] op_sel_hi:[1,1,1] neg_lo:[1,0,0] neg_hi:[1,0,0]
    v_pk_fma_f32 v[116:117], v[48:49], v[22:23], v[116:117] op_sel:[0,1,0] op_sel_hi:[1,1,1] neg_lo:[1,0,0] neg_hi:[1,0,0]
    v_pk_fma_f32 v[118:119], v[50:51], v[22:23], v[118:119] op_sel:[0,1,0] op_sel_hi:[1,1,1] neg_lo:[1,0,0] neg_hi:[1,0,0]
    v_pk_fma_f32 v[120:121], v[52:53], v[22:23], v[120:121] op_sel:[0,1,0] op_sel_hi:[1,1,1] neg_lo:[1,0,0] neg_hi:[1,0,0]
    v_pk_fma_f32 v[122:123], v[54:55], v[22:23], v[122:123] op_sel:[0,1,0] op_sel_hi:[1,1,1] neg_lo:[1,0,0] neg_hi:[1,0,0]
    v_pk_fma_f32 v[124:125], v[56:57], v[22:23], v[124:125] op_sel:[0,1,0] op_sel_hi:[1,1,1] neg_lo:[1,0,0] neg_hi:[1,0,0]
    v_pk_fma_f32 v[126:127], v[58:59], v[22:23], v[126:127] op_sel:[0,1,0] op_sel_hi:[1,1,1] neg_lo:[1,0,0] neg_hi:[1,0,0]
    v_cvt_pk_bf16_f32 v112, v112, v113
    v_cvt_pk_bf16_f32 v113, v114, v115
    v_cvt_pk_bf16_f32 v114, v116, v117
    v_cvt_pk_bf16_f32 v115, v118, v119
    v_cvt_pk_bf16_f32 v116, v120, v121
    v_cvt_pk_bf16_f32 v117, v122, v123
    v_cvt_pk_bf16_f32 v118, v124, v125
    v_cvt_pk_bf16_f32 v119, v126, v127
    v_pk_max_i16 v112, v112, 0
    v_pk_max_i16 v113, v113, 0
    v_pk_max_i16 v114, v114, 0
    v_pk_max_i16 v115, v115, 0
    v_pk_max_i16 v116, v116, 0
    v_pk_max_i16 v117, v117, 0
    v_pk_max_i16 v118, v118, 0
    v_pk_max_i16 v119, v119, 0
    s_add_u32 s67, s66, 4096
    buffer_store_dwordx4 v[112:115], v24, s[32:35], s67 offen sc1
    buffer_store_dwordx4 v[116:119], v24, s[32:35], s67 offen offset:512 sc1
    ds_read_b128 v[44:47], v21 offset:384
    ds_read_b128 v[48:51], v21 offset:416
    ds_read_b128 v[52:55], v21 offset:448
    ds_read_b128 v[56:59], v21 offset:480
    s_waitcnt lgkmcnt(4)
    v_pk_fma_f32 v[128:129], v[80:81], v[22:23], v[128:129] op_sel:[0,1,0] op_sel_hi:[1,1,1] neg_lo:[1,0,0] neg_hi:[1,0,0]
    v_pk_fma_f32 v[130:131], v[82:83], v[22:23], v[130:131] op_sel:[0,1,0] op_sel_hi:[1,1,1] neg_lo:[1,0,0] neg_hi:[1,0,0]
    v_pk_fma_f32 v[132:133], v[84:85], v[22:23], v[132:133] op_sel:[0,1,0] op_sel_hi:[1,1,1] neg_lo:[1,0,0] neg_hi:[1,0,0]
    v_pk_fma_f32 v[134:135], v[86:87], v[22:23], v[134:135] op_sel:[0,1,0] op_sel_hi:[1,1,1] neg_lo:[1,0,0] neg_hi:[1,0,0]
    v_pk_fma_f32 v[136:137], v[88:89], v[22:23], v[136:137] op_sel:[0,1,0] op_sel_hi:[1,1,1] neg_lo:[1,0,0] neg_hi:[1,0,0]
    v_pk_fma_f32 v[138:139], v[90:91], v[22:23], v[138:139] op_sel:[0,1,0] op_sel_hi:[1,1,1] neg_lo:[1,0,0] neg_hi:[1,0,0]
    v_pk_fma_f32 v[140:141], v[92:93], v[22:23], v[140:141] op_sel:[0,1,0] op_sel_hi:[1,1,1] neg_lo:[1,0,0] neg_hi:[1,0,0]
    v_pk_fma_f32 v[142:143], v[94:95], v[22:23], v[142:143] op_sel:[0,1,0] op_sel_hi:[1,1,1] neg_lo:[1,0,0] neg_hi:[1,0,0]
    v_cvt_pk_bf16_f32 v128, v128, v129
    v_cvt_pk_bf16_f32 v129, v130, v131
    v_cvt_pk_bf16_f32 v130, v132, v133
    v_cvt_pk_bf16_f32 v131, v134, v135
    v_cvt_pk_bf16_f32 v132, v136, v137
    v_cvt_pk_bf16_f32 v133, v138, v139
    v_cvt_pk_bf16_f32 v134, v140, v141
    v_cvt_pk_bf16_f32 v135, v142, v143
    v_pk_max_i16 v128, v128, 0
    v_pk_max_i16 v129, v129, 0
    v_pk_max_i16 v130, v130, 0
    v_pk_max_i16 v131, v131, 0
    v_pk_max_i16 v132, v132, 0
    v_pk_max_i16 v133, v133, 0
    v_pk_max_i16 v134, v134, 0
    v_pk_max_i16 v135, v135, 0
    s_add_u32 s67, s66, 8192
    buffer_store_dwordx4 v[128:131], v24, s[32:35], s67 offen sc1
    buffer_store_dwordx4 v[132:135], v24, s[32:35], s67 offen offset:512 sc1
    ds_read_b128 v[80:83], v21 offset:512
    ds_read_b128 v[84:87], v21 offset:544
    ds_read_b128 v[88:91], v21 offset:576
    ds_read_b128 v[92:95], v21 offset:608
    s_waitcnt lgkmcnt(4)
    v_pk_fma_f32 v[144:145], v[44:45], v[22:23], v[144:145] op_sel:[0,1,0] op_sel_hi:[1,1,1] neg_lo:[1,0,0] neg_hi:[1,0,0]
    v_pk_fma_f32 v[146:147], v[46:47], v[22:23], v[146:147] op_sel:[0,1,0] op_sel_hi:[1,1,1] neg_lo:[1,0,0] neg_hi:[1,0,0]
    v_pk_fma_f32 v[148:149], v[48:49], v[22:23], v[148:149] op_sel:[0,1,0] op_sel_hi:[1,1,1] neg_lo:[1,0,0] neg_hi:[1,0,0]
    v_pk_fma_f32 v[150:151], v[50:51], v[22:23], v[150:151] op_sel:[0,1,0] op_sel_hi:[1,1,1] neg_lo:[1,0,0] neg_hi:[1,0,0]
    v_pk_fma_f32 v[152:153], v[52:53], v[22:23], v[152:153] op_sel:[0,1,0] op_sel_hi:[1,1,1] neg_lo:[1,0,0] neg_hi:[1,0,0]
    v_pk_fma_f32 v[154:155], v[54:55], v[22:23], v[154:155] op_sel:[0,1,0] op_sel_hi:[1,1,1] neg_lo:[1,0,0] neg_hi:[1,0,0]
    v_pk_fma_f32 v[156:157], v[56:57], v[22:23], v[156:157] op_sel:[0,1,0] op_sel_hi:[1,1,1] neg_lo:[1,0,0] neg_hi:[1,0,0]
    v_pk_fma_f32 v[158:159], v[58:59], v[22:23], v[158:159] op_sel:[0,1,0] op_sel_hi:[1,1,1] neg_lo:[1,0,0] neg_hi:[1,0,0]
    v_cvt_pk_bf16_f32 v144, v144, v145
    v_cvt_pk_bf16_f32 v145, v146, v147
    v_cvt_pk_bf16_f32 v146, v148, v149
    v_cvt_pk_bf16_f32 v147, v150, v151
    v_cvt_pk_bf16_f32 v148, v152, v153
    v_cvt_pk_bf16_f32 v149, v154, v155
    v_cvt_pk_bf16_f32 v150, v156, v157
    v_cvt_pk_bf16_f32 v151, v158, v159
    v_pk_max_i16 v144, v144, 0
    v_pk_max_i16 v145, v145, 0
    v_pk_max_i16 v146, v146, 0
    v_pk_max_i16 v147, v147, 0
    v_pk_max_i16 v148, v148, 0
    v_pk_max_i16 v149, v149, 0
    v_pk_max_i16 v150, v150, 0
    v_pk_max_i16 v151, v151, 0
    s_add_u32 s67, s66, 12288
    buffer_store_dwordx4 v[144:147], v24, s[32:35], s67 offen sc1
    buffer_store_dwordx4 v[148:151], v24, s[32:35], s67 offen offset:512 sc1
    ds_read_b128 v[44:47], v21 offset:640
    ds_read_b128 v[48:51], v21 offset:672
    ds_read_b128 v[52:55], v21 offset:704
    ds_read_b128 v[56:59], v21 offset:736
    s_waitcnt lgkmcnt(4)
    v_pk_fma_f32 v[160:161], v[80:81], v[22:23], v[160:161] op_sel:[0,1,0] op_sel_hi:[1,1,1] neg_lo:[1,0,0] neg_hi:[1,0,0]
    v_pk_fma_f32 v[162:163], v[82:83], v[22:23], v[162:163] op_sel:[0,1,0] op_sel_hi:[1,1,1] neg_lo:[1,0,0] neg_hi:[1,0,0]
    v_pk_fma_f32 v[164:165], v[84:85], v[22:23], v[164:165] op_sel:[0,1,0] op_sel_hi:[1,1,1] neg_lo:[1,0,0] neg_hi:[1,0,0]
    v_pk_fma_f32 v[166:167], v[86:87], v[22:23], v[166:167] op_sel:[0,1,0] op_sel_hi:[1,1,1] neg_lo:[1,0,0] neg_hi:[1,0,0]
    v_pk_fma_f32 v[168:169], v[88:89], v[22:23], v[168:169] op_sel:[0,1,0] op_sel_hi:[1,1,1] neg_lo:[1,0,0] neg_hi:[1,0,0]
    v_pk_fma_f32 v[170:171], v[90:91], v[22:23], v[170:171] op_sel:[0,1,0] op_sel_hi:[1,1,1] neg_lo:[1,0,0] neg_hi:[1,0,0]
    v_pk_fma_f32 v[172:173], v[92:93], v[22:23], v[172:173] op_sel:[0,1,0] op_sel_hi:[1,1,1] neg_lo:[1,0,0] neg_hi:[1,0,0]
    v_pk_fma_f32 v[174:175], v[94:95], v[22:23], v[174:175] op_sel:[0,1,0] op_sel_hi:[1,1,1] neg_lo:[1,0,0] neg_hi:[1,0,0]
    v_cvt_pk_bf16_f32 v160, v160, v161
    v_cvt_pk_bf16_f32 v161, v162, v163
    v_cvt_pk_bf16_f32 v162, v164, v165
    v_cvt_pk_bf16_f32 v163, v166, v167
    v_cvt_pk_bf16_f32 v164, v168, v169
    v_cvt_pk_bf16_f32 v165, v170, v171
    v_cvt_pk_bf16_f32 v166, v172, v173
    v_cvt_pk_bf16_f32 v167, v174, v175
    v_pk_max_i16 v160, v160, 0
    v_pk_max_i16 v161, v161, 0
    v_pk_max_i16 v162, v162, 0
    v_pk_max_i16 v163, v163, 0
    v_pk_max_i16 v164, v164, 0
    v_pk_max_i16 v165, v165, 0
    v_pk_max_i16 v166, v166, 0
    v_pk_max_i16 v167, v167, 0
    s_add_u32 s67, s66, 16384
    buffer_store_dwordx4 v[160:163], v24, s[32:35], s67 offen sc1
    buffer_store_dwordx4 v[164:167], v24, s[32:35], s67 offen offset:512 sc1
    ds_read_b128 v[80:83], v21 offset:768
    ds_read_b128 v[84:87], v21 offset:800
    ds_read_b128 v[88:91], v21 offset:832
    ds_read_b128 v[92:95], v21 offset:864
    s_waitcnt lgkmcnt(4)
    v_pk_fma_f32 v[176:177], v[44:45], v[22:23], v[176:177] op_sel:[0,1,0] op_sel_hi:[1,1,1] neg_lo:[1,0,0] neg_hi:[1,0,0]
    v_pk_fma_f32 v[178:179], v[46:47], v[22:23], v[178:179] op_sel:[0,1,0] op_sel_hi:[1,1,1] neg_lo:[1,0,0] neg_hi:[1,0,0]
    v_pk_fma_f32 v[180:181], v[48:49], v[22:23], v[180:181] op_sel:[0,1,0] op_sel_hi:[1,1,1] neg_lo:[1,0,0] neg_hi:[1,0,0]
    v_pk_fma_f32 v[182:183], v[50:51], v[22:23], v[182:183] op_sel:[0,1,0] op_sel_hi:[1,1,1] neg_lo:[1,0,0] neg_hi:[1,0,0]
    v_pk_fma_f32 v[184:185], v[52:53], v[22:23], v[184:185] op_sel:[0,1,0] op_sel_hi:[1,1,1] neg_lo:[1,0,0] neg_hi:[1,0,0]
    v_pk_fma_f32 v[186:187], v[54:55], v[22:23], v[186:187] op_sel:[0,1,0] op_sel_hi:[1,1,1] neg_lo:[1,0,0] neg_hi:[1,0,0]
    v_pk_fma_f32 v[188:189], v[56:57], v[22:23], v[188:189] op_sel:[0,1,0] op_sel_hi:[1,1,1] neg_lo:[1,0,0] neg_hi:[1,0,0]
    v_pk_fma_f32 v[190:191], v[58:59], v[22:23], v[190:191] op_sel:[0,1,0] op_sel_hi:[1,1,1] neg_lo:[1,0,0] neg_hi:[1,0,0]
    v_cvt_pk_bf16_f32 v176, v176, v177
    v_cvt_pk_bf16_f32 v177, v178, v179
    v_cvt_pk_bf16_f32 v178, v180, v181
    v_cvt_pk_bf16_f32 v179, v182, v183
    v_cvt_pk_bf16_f32 v180, v184, v185
    v_cvt_pk_bf16_f32 v181, v186, v187
    v_cvt_pk_bf16_f32 v182, v188, v189
    v_cvt_pk_bf16_f32 v183, v190, v191
    v_pk_max_i16 v176, v176, 0
    v_pk_max_i16 v177, v177, 0
    v_pk_max_i16 v178, v178, 0
    v_pk_max_i16 v179, v179, 0
    v_pk_max_i16 v180, v180, 0
    v_pk_max_i16 v181, v181, 0
    v_pk_max_i16 v182, v182, 0
    v_pk_max_i16 v183, v183, 0
    s_add_u32 s67, s66, 20480
    buffer_store_dwordx4 v[176:179], v24, s[32:35], s67 offen sc1
    buffer_store_dwordx4 v[180:183], v24, s[32:35], s67 offen offset:512 sc1
    buffer_load_dword v5, v247, s[32:35], s59 offen sc1
    ds_read_b128 v[44:47], v21 offset:896
    ds_read_b128 v[48:51], v21 offset:928
    ds_read_b128 v[52:55], v21 offset:960
    ds_read_b128 v[56:59], v21 offset:992
    s_waitcnt lgkmcnt(4)
    v_pk_fma_f32 v[192:193], v[80:81], v[22:23], v[192:193] op_sel:[0,1,0] op_sel_hi:[1,1,1] neg_lo:[1,0,0] neg_hi:[1,0,0]
    v_pk_fma_f32 v[194:195], v[82:83], v[22:23], v[194:195] op_sel:[0,1,0] op_sel_hi:[1,1,1] neg_lo:[1,0,0] neg_hi:[1,0,0]
    v_pk_fma_f32 v[196:197], v[84:85], v[22:23], v[196:197] op_sel:[0,1,0] op_sel_hi:[1,1,1] neg_lo:[1,0,0] neg_hi:[1,0,0]
    v_pk_fma_f32 v[198:199], v[86:87], v[22:23], v[198:199] op_sel:[0,1,0] op_sel_hi:[1,1,1] neg_lo:[1,0,0] neg_hi:[1,0,0]
    v_pk_fma_f32 v[200:201], v[88:89], v[22:23], v[200:201] op_sel:[0,1,0] op_sel_hi:[1,1,1] neg_lo:[1,0,0] neg_hi:[1,0,0]
    v_pk_fma_f32 v[202:203], v[90:91], v[22:23], v[202:203] op_sel:[0,1,0] op_sel_hi:[1,1,1] neg_lo:[1,0,0] neg_hi:[1,0,0]
    v_pk_fma_f32 v[204:205], v[92:93], v[22:23], v[204:205] op_sel:[0,1,0] op_sel_hi:[1,1,1] neg_lo:[1,0,0] neg_hi:[1,0,0]
    v_pk_fma_f32 v[206:207], v[94:95], v[22:23], v[206:207] op_sel:[0,1,0] op_sel_hi:[1,1,1] neg_lo:[1,0,0] neg_hi:[1,0,0]
    v_pk_fma_f32 v[192:193], v[192:193], v[22:23], s[74:75] op_sel:[0,0,0] op_sel_hi:[1,0,1]
    v_pk_fma_f32 v[194:195], v[194:195], v[22:23], s[74:75] op_sel:[0,0,0] op_sel_hi:[1,0,1]
    v_pk_fma_f32 v[196:197], v[196:197], v[22:23], s[74:75] op_sel:[0,0,0] op_sel_hi:[1,0,1]
    v_pk_fma_f32 v[198:199], v[198:199], v[22:23], s[74:75] op_sel:[0,0,0] op_sel_hi:[1,0,1]
    v_pk_fma_f32 v[200:201], v[200:201], v[22:23], s[74:75] op_sel:[0,0,0] op_sel_hi:[1,0,1]
    v_pk_fma_f32 v[202:203], v[202:203], v[22:23], s[74:75] op_sel:[0,0,0] op_sel_hi:[1,0,1]
    v_pk_fma_f32 v[204:205], v[204:205], v[22:23], s[74:75] op_sel:[0,0,0] op_sel_hi:[1,0,1]
    v_pk_fma_f32 v[206:207], v[206:207], v[22:23], s[74:75] op_sel:[0,0,0] op_sel_hi:[1,0,1]
    v_pk_mul_f32 v[80:81], v[192:193], s[52:53]
    v_pk_mul_f32 v[82:83], v[194:195], s[52:53]
    v_pk_mul_f32 v[84:85], v[196:197], s[52:53]
    v_pk_mul_f32 v[86:87], v[198:199], s[52:53]
    v_pk_mul_f32 v[88:89], v[200:201], s[52:53]
    v_pk_mul_f32 v[90:91], v[202:203], s[52:53]
    v_pk_mul_f32 v[92:93], v[204:205], s[52:53]
    v_pk_mul_f32 v[94:95], v[206:207], s[52:53]
    v_exp_f32_e64 v80, v80 clamp
    v_max_f32 v192, s64, v192
    v_exp_f32_e64 v81, v81 clamp
    v_max_f32 v193, s64, v193
    v_exp_f32_e64 v82, v82 clamp
    v_max_f32 v194, s64, v194
    v_exp_f32_e64 v83, v83 clamp
    v_max_f32 v195, s64, v195
    v_exp_f32_e64 v84, v84 clamp
    v_max_f32 v196, s64, v196
    v_exp_f32_e64 v85, v85 clamp
    v_max_f32 v197, s64, v197
    v_exp_f32_e64 v86, v86 clamp
    v_max_f32 v198, s64, v198
    v_exp_f32_e64 v87, v87 clamp
    v_max_f32 v199, s64, v199
    v_exp_f32_e64 v88, v88 clamp
    v_max_f32 v200, s64, v200
    v_exp_f32_e64 v89, v89 clamp
    v_max_f32 v201, s64, v201
    v_exp_f32_e64 v90, v90 clamp
    v_max_f32 v202, s64, v202
    v_exp_f32_e64 v91, v91 clamp
    v_max_f32 v203, s64, v203
    v_exp_f32_e64 v92, v92 clamp
    v_max_f32 v204, s64, v204
    v_exp_f32_e64 v93, v93 clamp
    v_max_f32 v205, s64, v205
    v_exp_f32_e64 v94, v94 clamp
    v_max_f32 v206, s64, v206
    v_exp_f32_e64 v95, v95 clamp
    v_max_f32 v207, s64, v207
    v_pk_add_f32 v[192:193], v[192:193], v[80:81]
    v_pk_add_f32 v[194:195], v[194:195], v[82:83]
    v_pk_add_f32 v[196:197], v[196:197], v[84:85]
    v_pk_add_f32 v[198:199], v[198:199], v[86:87]
    v_pk_add_f32 v[200:201], v[200:201], v[88:89]
    v_pk_add_f32 v[202:203], v[202:203], v[90:91]
    v_pk_add_f32 v[204:205], v[204:205], v[92:93]
    v_pk_add_f32 v[206:207], v[206:207], v[94:95]
    v_cvt_pk_bf16_f32 v192, v192, v193
    v_cvt_pk_bf16_f32 v193, v194, v195
    v_cvt_pk_bf16_f32 v194, v196, v197
    v_cvt_pk_bf16_f32 v195, v198, v199
    v_cvt_pk_bf16_f32 v196, v200, v201
    v_cvt_pk_bf16_f32 v197, v202, v203
    v_cvt_pk_bf16_f32 v198, v204, v205
    v_cvt_pk_bf16_f32 v199, v206, v207
    ds_read_b128 v[80:83], v21 offset:1024
    ds_read_b128 v[84:87], v21 offset:1056
    s_waitcnt lgkmcnt(2)
    v_pk_fma_f32 v[208:209], v[44:45], v[22:23], v[208:209] op_sel:[0,1,0] op_sel_hi:[1,1,1] neg_lo:[1,0,0] neg_hi:[1,0,0]
    v_pk_fma_f32 v[210:211], v[46:47], v[22:23], v[210:211] op_sel:[0,1,0] op_sel_hi:[1,1,1] neg_lo:[1,0,0] neg_hi:[1,0,0]
    v_pk_fma_f32 v[212:213], v[48:49], v[22:23], v[212:213] op_sel:[0,1,0] op_sel_hi:[1,1,1] neg_lo:[1,0,0] neg_hi:[1,0,0]
    v_pk_fma_f32 v[214:215], v[50:51], v[22:23], v[214:215] op_sel:[0,1,0] op_sel_hi:[1,1,1] neg_lo:[1,0,0] neg_hi:[1,0,0]
    v_pk_fma_f32 v[216:217], v[52:53], v[22:23], v[216:217] op_sel:[0,1,0] op_sel_hi:[1,1,1] neg_lo:[1,0,0] neg_hi:[1,0,0]
    v_pk_fma_f32 v[218:219], v[54:55], v[22:23], v[218:219] op_sel:[0,1,0] op_sel_hi:[1,1,1] neg_lo:[1,0,0] neg_hi:[1,0,0]
    v_pk_fma_f32 v[220:221], v[56:57], v[22:23], v[220:221] op_sel:[0,1,0] op_sel_hi:[1,1,1] neg_lo:[1,0,0] neg_hi:[1,0,0]
    v_pk_fma_f32 v[222:223], v[58:59], v[22:23], v[222:223] op_sel:[0,1,0] op_sel_hi:[1,1,1] neg_lo:[1,0,0] neg_hi:[1,0,0]
    v_pk_fma_f32 v[208:209], v[208:209], v[22:23], s[74:75] op_sel:[0,0,0] op_sel_hi:[1,0,1]
    v_pk_fma_f32 v[210:211], v[210:211], v[22:23], s[74:75] op_sel:[0,0,0] op_sel_hi:[1,0,1]
    v_pk_fma_f32 v[212:213], v[212:213], v[22:23], s[74:75] op_sel:[0,0,0] op_sel_hi:[1,0,1]
    v_pk_fma_f32 v[214:215], v[214:215], v[22:23], s[74:75] op_sel:[0,0,0] op_sel_hi:[1,0,1]
    v_pk_fma_f32 v[216:217], v[216:217], v[22:23], s[74:75] op_sel:[0,0,0] op_sel_hi:[1,0,1]
    v_pk_fma_f32 v[218:219], v[218:219], v[22:23], s[74:75] op_sel:[0,0,0] op_sel_hi:[1,0,1]
    v_pk_fma_f32 v[220:221], v[220:221], v[22:23], s[74:75] op_sel:[0,0,0] op_sel_hi:[1,0,1]
    v_pk_fma_f32 v[222:223], v[222:223], v[22:23], s[74:75] op_sel:[0,0,0] op_sel_hi:[1,0,1]
    v_pk_mul_f32 v[44:45], v[208:209], s[52:53]
    v_pk_mul_f32 v[46:47], v[210:211], s[52:53]
    v_pk_mul_f32 v[48:49], v[212:213], s[52:53]
    v_pk_mul_f32 v[50:51], v[214:215], s[52:53]
    v_pk_mul_f32 v[52:53], v[216:217], s[52:53]
    v_pk_mul_f32 v[54:55], v[218:219], s[52:53]
    v_pk_mul_f32 v[56:57], v[220:221], s[52:53]
    v_pk_mul_f32 v[58:59], v[222:223], s[52:53]
    v_exp_f32_e64 v44, v44 clamp
    v_max_f32 v208, s64, v208
    v_exp_f32_e64 v45, v45 clamp
    v_max_f32 v209, s64, v209
    v_exp_f32_e64 v46, v46 clamp
    v_max_f32 v210, s64, v210
    v_exp_f32_e64 v47, v47 clamp
    v_max_f32 v211, s64, v211
    v_exp_f32_e64 v48, v48 clamp
    v_max_f32 v212, s64, v212
    v_exp_f32_e64 v49, v49 clamp
    v_max_f32 v213, s64, v213
    v_exp_f32_e64 v50, v50 clamp
    v_max_f32 v214, s64, v214
    v_exp_f32_e64 v51, v51 clamp
    v_max_f32 v215, s64, v215
    v_exp_f32_e64 v52, v52 clamp
    v_max_f32 v216, s64, v216
    v_exp_f32_e64 v53, v53 clamp
    v_max_f32 v217, s64, v217
    v_exp_f32_e64 v54, v54 clamp
    v_max_f32 v218, s64, v218
    v_exp_f32_e64 v55, v55 clamp
    v_max_f32 v219, s64, v219
    v_exp_f32_e64 v56, v56 clamp
    v_max_f32 v220, s64, v220
    v_exp_f32_e64 v57, v57 clamp
    v_max_f32 v221, s64, v221
    v_exp_f32_e64 v58, v58 clamp
    v_max_f32 v222, s64, v222
    v_exp_f32_e64 v59, v59 clamp
    v_max_f32 v223, s64, v223
    v_pk_add_f32 v[208:209], v[208:209], v[44:45]
    v_pk_add_f32 v[210:211], v[210:211], v[46:47]
    v_pk_add_f32 v[212:213], v[212:213], v[48:49]
    v_pk_add_f32 v[214:215], v[214:215], v[50:51]
    v_pk_add_f32 v[216:217], v[216:217], v[52:53]
    v_pk_add_f32 v[218:219], v[218:219], v[54:55]
    v_pk_add_f32 v[220:221], v[220:221], v[56:57]
    v_pk_add_f32 v[222:223], v[222:223], v[58:59]
    v_cvt_pk_bf16_f32 v208, v208, v209
    v_cvt_pk_bf16_f32 v209, v210, v211
    v_cvt_pk_bf16_f32 v210, v212, v213
    v_cvt_pk_bf16_f32 v211, v214, v215
    v_cvt_pk_bf16_f32 v212, v216, v217
    v_cvt_pk_bf16_f32 v213, v218, v219
    v_cvt_pk_bf16_f32 v214, v220, v221
    v_cvt_pk_bf16_f32 v215, v222, v223
    s_waitcnt vmcnt(0)
    v_mov_b32 v8, 1
    s_mov_b64 exec, 1
    ds_add_rtn_u32 v9, v26, v8 offset:0
    s_mov_b64 exec, -1
    s_waitcnt lgkmcnt(0)
    v_readfirstlane_b32 s60, v9
    s_nop 0
    s_cmp_eq_u32 s60, 3
    s_cbranch_scc0 L_pf_hB
    v_lshlrev_b32 v8, 7, v0
    v_mov_b32 v9, 1
    s_lshl_b32 s60, s44, 11
    s_lshl_b32 s61, s45, 2
    s_add_u32 s60, s60, s61
    s_add_u32 s60, s60, 14090240
    s_mov_b64 exec, 0xffff
    buffer_store_dword v9, v8, s[32:35], s60 offen sc1
    s_mov_b64 exec, -1
L_pf_hB:
    s_waitcnt lgkmcnt(0)
    v_pk_fma_f32 v[224:225], v[80:81], v[22:23], v[224:225] op_sel:[0,1,0] op_sel_hi:[1,1,1] neg_lo:[1,0,0] neg_hi:[1,0,0]
    v_pk_fma_f32 v[226:227], v[82:83], v[22:23], v[226:227] op_sel:[0,1,0] op_sel_hi:[1,1,1] neg_lo:[1,0,0] neg_hi:[1,0,0]
    v_pk_fma_f32 v[228:229], v[84:85], v[22:23], v[228:229] op_sel:[0,1,0] op_sel_hi:[1,1,1] neg_lo:[1,0,0] neg_hi:[1,0,0]
    v_pk_fma_f32 v[230:231], v[86:87], v[22:23], v[230:231] op_sel:[0,1,0] op_sel_hi:[1,1,1] neg_lo:[1,0,0] neg_hi:[1,0,0]
    v_pk_fma_f32 v[224:225], v[224:225], v[22:23], s[74:75] op_sel:[0,0,0] op_sel_hi:[1,0,1]
    v_pk_fma_f32 v[226:227], v[226:227], v[22:23], s[74:75] op_sel:[0,0,0] op_sel_hi:[1,0,1]
    v_pk_fma_f32 v[228:229], v[228:229], v[22:23], s[74:75] op_sel:[0,0,0] op_sel_hi:[1,0,1]
    v_pk_fma_f32 v[230:231], v[230:231], v[22:23], s[74:75] op_sel:[0,0,0] op_sel_hi:[1,0,1]
    v_pk_mul_f32 v[80:81], v[224:225], s[52:53]
    v_pk_mul_f32 v[82:83], v[226:227], s[52:53]
    v_pk_mul_f32 v[84:85], v[228:229], s[52:53]
    v_pk_mul_f32 v[86:87], v[230:231], s[52:53]
    v_exp_f32_e64 v80, v80 clamp
    v_max_f32 v224, s64, v224
    v_exp_f32_e64 v81, v81 clamp
    v_max_f32 v225, s64, v225
    v_exp_f32_e64 v82, v82 clamp
    v_max_f32 v226, s64, v226
    v_exp_f32_e64 v83, v83 clamp
    v_max_f32 v227, s64, v227
    v_exp_f32_e64 v84, v84 clamp
    v_max_f32 v228, s64, v228
    v_exp_f32_e64 v85, v85 clamp
    v_max_f32 v229, s64, v229
    v_exp_f32_e64 v86, v86 clamp
    v_max_f32 v230, s64, v230
    v_exp_f32_e64 v87, v87 clamp
    v_max_f32 v231, s64, v231
    v_pk_add_f32 v[224:225], v[224:225], v[80:81]
    v_pk_add_f32 v[226:227], v[226:227], v[82:83]
    v_pk_add_f32 v[228:229], v[228:229], v[84:85]
    v_pk_add_f32 v[230:231], v[230:231], v[86:87]
    v_cvt_pk_bf16_f32 v224, v224, v225
    v_cvt_pk_bf16_f32 v225, v226, v227
    v_cvt_pk_bf16_f32 v226, v228, v229
    v_cvt_pk_bf16_f32 v227, v230, v231
    s_mov_b32 s62, 0
L_kv_chk:
    v_cmp_ne_u32 vcc, 1, v5
    s_nop 0
    s_and_b32 s60, vcc_lo, 0xffff
    s_cbranch_scc0 L_kv_ok
    s_sleep 2
    buffer_load_dword v5, v247, s[32:35], s59 offen sc1
    s_add_u32 s62, s62, 1
    s_cmp_lt_u32 s62, 0x80000
    s_waitcnt vmcnt(0)
    s_cbranch_scc1 L_kv_chk
L_kv_ok:
    s_lshl_b32 s61, s45, 13
    s_add_u32 s61, s61, 12582912
    buffer_load_dwordx4 v[64:67], v245, s[32:35], s61 offen sc1
    buffer_load_dwordx4 v[68:71], v246, s[32:35], s61 offen sc1
    s_mov_b32 s62, 0
L_sp_zf:
    ds_read_b32 v5, v26 offset:32
    s_waitcnt lgkmcnt(0)
    v_readfirstlane_b32 s60, v5
    s_nop 0
    s_cmp_ge_u32 s60, 4
    s_cbranch_scc1 L_spd_zf
    s_sleep 1
    s_add_u32 s62, s62, 1
    s_cmp_lt_u32 s62, 0x800000
    s_cbranch_scc1 L_sp_zf
L_spd_zf:
    s_waitcnt vmcnt(0)
    v_cvt_pk_bf16_f32 v72, v64, v65
    v_cvt_pk_bf16_f32 v73, v66, v67
    v_cvt_pk_bf16_f32 v74, v68, v69
    v_cvt_pk_bf16_f32 v75, v70, v71
    ds_write_b64 v240, v[72:73]
    v_cmp_gt_u32 vcc, 420, v244
    s_nop 0
    s_and_saveexec_b64 s[60:61], vcc
    ds_write_b64 v241, v[74:75]
    v_cmp_lt_u32 vcc, 399, v244
    s_nop 0
    s_and_b64 exec, exec, vcc
    ds_write_b64 v241, v[74:75] offset:640
    s_mov_b64 exec, s[60:61]
    s_waitcnt lgkmcnt(0)
    v_mov_b32 v8, 1
    s_mov_b64 exec, 1
    ds_add_u32 v26, v8 offset:16
    s_mov_b64 exec, -1
    s_mov_b32 s62, 0
L_sp_kvi:
    ds_read_b32 v5, v26 offset:16
    s_waitcnt lgkmcnt(0)
    v_readfirstlane_b32 s60, v5
    s_nop 0
    s_cmp_ge_u32 s60, 4
    s_cbranch_scc1 L_spd_kvi
    s_sleep 1
    s_add_u32 s62, s62, 1
    s_cmp_lt_u32 s62, 0x800000
    s_cbranch_scc1 L_sp_kvi
L_spd_kvi:
    ds_read_b128 v[72:75], v243 offset:0
    ds_read_b128 v[76:79], v243 offset:32
    ds_read_b128 v[80:83], v243 offset:64
    ds_read_b128 v[84:87], v243 offset:96
    ds_read_b128 v[88:91], v243 offset:128
    ds_read_b128 v[44:47], v242 offset:0
    ds_read_b128 v[48:51], v242 offset:32
    ds_read_b128 v[52:55], v242 offset:64
    ds_read_b128 v[56:59], v242 offset:39968
    ds_read_b128 v[60:63], v242 offset:40000
    ds_read_b128 v[64:67], v242 offset:40032
    ds_read_b128 v[68:71], v242 offset:40064
    s_waitcnt lgkmcnt(11)
    v_mfma_f32_32x32x16_bf16 v[128:143], v[72:75], v[192:195], 0
    s_waitcnt lgkmcnt(10)
    v_mfma_f32_32x32x16_bf16 v[128:143], v[76:79], v[196:199], v[128:143]
    s_waitcnt lgkmcnt(9)
    v_mfma_f32_32x32x16_bf16 v[128:143], v[80:83], v[208:211], v[128:143]
    s_waitcnt lgkmcnt(8)
    v_mfma_f32_32x32x16_bf16 v[128:143], v[84:87], v[212:215], v[128:143]
    s_waitcnt lgkmcnt(7)
    v_mfma_f32_32x32x16_bf16 v[128:143], v[88:91], v[224:227], v[128:143]
    s_waitcnt lgkmcnt(6)
    v_mfma_f32_32x32x16_bf16 v[96:111], v[44:47], v[192:195], 0
    s_waitcnt lgkmcnt(5)
    v_mfma_f32_32x32x16_bf16 v[96:111], v[48:51], v[196:199], v[96:111]
    s_waitcnt lgkmcnt(4)
    v_mfma_f32_32x32x16_bf16 v[96:111], v[52:55], v[208:211], v[96:111]
    s_waitcnt lgkmcnt(3)
    v_mfma_f32_32x32x16_bf16 v[112:127], v[56:59], v[196:199], 0
    s_waitcnt lgkmcnt(2)
    v_mfma_f32_32x32x16_bf16 v[112:127], v[60:63], v[208:211], v[112:127]
    s_waitcnt lgkmcnt(1)
    v_mfma_f32_32x32x16_bf16 v[112:127], v[64:67], v[212:215], v[112:127]
    s_waitcnt lgkmcnt(0)
    v_mfma_f32_32x32x16_bf16 v[112:127], v[68:71], v[224:227], v[112:127]
    v_add_f32 v4, s64, v136
    v_add_f32 v5, s64, v137
    v_add_f32 v6, s64, v138
    v_add_f32 v7, s64, v139
    v_mul_f32 v4, v22, v4
    v_mul_f32 v5, v22, v5
    v_mul_f32 v6, v22, v6
    v_mul_f32 v7, v22, v7
    v_rcp_f32 v4, v4
    v_rcp_f32 v5, v5
    v_rcp_f32 v6, v6
    v_rcp_f32 v7, v7
    s_mul_i32 s60, s45, 5
    v_mul_f32 v128, v7, v128
    v_mul_f32 v129, v7, v129
    v_mul_f32 v130, v7, v130
    v_mul_f32 v131, v7, v131
    v_mul_f32 v132, v7, v132
    v_mul_f32 v133, v7, v133
    v_mul_f32 v134, v7, v134
    v_mul_f32 v135, v7, v135
    v_cvt_pk_bf16_f32 v128, v128, v129
    v_cvt_pk_bf16_f32 v129, v130, v131
    v_cvt_pk_bf16_f32 v130, v132, v133
    v_cvt_pk_bf16_f32 v131, v134, v135
    s_add_u32 s61, s60, 4
    s_lshr_b32 s67, s61, 1
    s_add_u32 s67, s67, 48
    s_lshl_b32 s67, s67, 12
    s_and_b32 s61, s61, 1
    s_lshl_b32 s61, s61, 9
    s_add_u32 s67, s67, s61
    s_add_u32 s67, s67, s65
    buffer_store_dwordx4 v[128:131], v24, s[32:35], s67 offen sc1
    v_mul_f32 v96, v4, v96
    v_mul_f32 v97, v4, v97
    v_mul_f32 v98, v4, v98
    v_mul_f32 v99, v4, v99
    v_mul_f32 v100, v4, v100
    v_mul_f32 v101, v4, v101
    v_mul_f32 v102, v4, v102
    v_mul_f32 v103, v4, v103
    v_cvt_pk_bf16_f32 v96, v96, v97
    v_cvt_pk_bf16_f32 v97, v98, v99
    v_cvt_pk_bf16_f32 v98, v100, v101
    v_cvt_pk_bf16_f32 v99, v102, v103
    s_add_u32 s61, s60, 0
    s_lshr_b32 s67, s61, 1
    s_add_u32 s67, s67, 48
    s_lshl_b32 s67, s67, 12
    s_and_b32 s61, s61, 1
    s_lshl_b32 s61, s61, 9
    s_add_u32 s67, s67, s61
    s_add_u32 s67, s67, s65
    buffer_store_dwordx4 v[96:99], v24, s[32:35], s67 offen sc1
    v_cndmask_b32 v8, v4, v5, s[76:77]
    v_mul_f32 v104, v8, v104
    v_mul_f32 v105, v8, v105
    v_mul_f32 v106, v8, v106
    v_mul_f32 v107, v8, v107
    v_mul_f32 v108, v5, v108
    v_mul_f32 v109, v5, v109
    v_mul_f32 v110, v5, v110
    v_mul_f32 v111, v5, v111
    v_cvt_pk_bf16_f32 v104, v104, v105
    v_cvt_pk_bf16_f32 v105, v106, v107
    v_cvt_pk_bf16_f32 v106, v108, v109
    v_cvt_pk_bf16_f32 v107, v110, v111
    s_add_u32 s61, s60, 1
    s_lshr_b32 s67, s61, 1
    s_add_u32 s67, s67, 48
    s_lshl_b32 s67, s67, 12
    s_and_b32 s61, s61, 1
    s_lshl_b32 s61, s61, 9
    s_add_u32 s67, s67, s61
    s_add_u32 s67, s67, s65
    buffer_store_dwordx4 v[104:107], v24, s[32:35], s67 offen sc1
    v_mul_f32 v112, v5, v112
    v_mul_f32 v113, v5, v113
    v_mul_f32 v114, v5, v114
    v_mul_f32 v115, v5, v115
    v_mul_f32 v116, v6, v116
    v_mul_f32 v117, v6, v117
    v_mul_f32 v118, v6, v118
    v_mul_f32 v119, v6, v119
    v_cvt_pk_bf16_f32 v112, v112, v113
    v_cvt_pk_bf16_f32 v113, v114, v115
    v_cvt_pk_bf16_f32 v114, v116, v117
    v_cvt_pk_bf16_f32 v115, v118, v119
    s_add_u32 s61, s60, 2
    s_lshr_b32 s67, s61, 1
    s_add_u32 s67, s67, 48
    s_lshl_b32 s67, s67, 12
    s_and_b32 s61, s61, 1
    s_lshl_b32 s61, s61, 9
    s_add_u32 s67, s67, s61
    s_add_u32 s67, s67, s65
    buffer_store_dwordx4 v[112:115], v24, s[32:35], s67 offen sc1
    v_mul_f32 v120, v6, v120
    v_mul_f32 v121, v6, v121
    v_mul_f32 v122, v6, v122
    v_mul_f32 v123, v6, v123
    v_cndmask_b32 v8, v6, v7, s[76:77]
    v_mul_f32 v124, v8, v124
    v_mul_f32 v125, v8, v125
    v_mul_f32 v126, v8, v126
    v_mul_f32 v127, v8, v127
    v_cvt_pk_bf16_f32 v120, v120, v121
    v_cvt_pk_bf16_f32 v121, v122, v123
    v_cvt_pk_bf16_f32 v122, v124, v125
    v_cvt_pk_bf16_f32 v123, v126, v127
    s_add_u32 s61, s60, 3
    s_lshr_b32 s67, s61, 1
    s_add_u32 s67, s67, 48
    s_lshl_b32 s67, s67, 12
    s_and_b32 s61, s61, 1
    s_lshl_b32 s61, s61, 9
    s_add_u32 s67, s67, s61
    s_add_u32 s67, s67, s65
    buffer_store_dwordx4 v[120:123], v24, s[32:35], s67 offen sc1
    s_waitcnt vmcnt(0)
    v_mov_b32 v8, 1
    s_mov_b64 exec, 1
    ds_add_rtn_u32 v9, v26, v8 offset:20
    s_mov_b64 exec, -1
    s_waitcnt lgkmcnt(0)
    v_readfirstlane_b32 s60, v9
    s_nop 0
    s_cmp_eq_u32 s60, 3
    s_cbranch_scc0 L_pf_oB
    v_lshlrev_b32 v8, 7, v0
    v_mov_b32 v9, 2
    s_lshl_b32 s60, s44, 11
    s_lshl_b32 s61, s45, 2
    s_add_u32 s60, s60, s61
    s_add_u32 s60, s60, 14090240
    s_mov_b64 exec, 0xffff
    buffer_store_dword v9, v8, s[32:35], s60 offen sc1
    s_mov_b64 exec, -1
L_pf_oB:
    s_endpgm
L_coA:
    s_add_u32 s60, s68, 5120
    s_add_u32 s61, s68, 12288
    v_mov_b32 v30, s61
    v_lshl_add_u32 v30, v0, 4, v30
    v_add_u32 v4, 4294967280, v1
    v_mul_u32_u24 v28, 205, v4
    v_lshrrev_b32 v28, 12, v28
    v_mul_u32_u24 v28, 5, v28
    v_sub_u32 v31, v2, v28
    v_mul_u32_u24 v4, 5, v4
    v_add_u32 v4, v4, v31
    v_lshlrev_b32 v4, 4, v4
    v_add_u32 v5, s60, v4
    v_cmp_gt_u32 vcc, 16, v1
    v_mov_b32 v28, 1000
    s_nop 0
    v_cndmask_b32 v31, v31, v28, vcc
    v_add_u32 v4, 16, v1
    v_mul_u32_u24 v28, 205, v4
    v_lshrrev_b32 v28, 12, v28
    v_mul_u32_u24 v28, 5, v28
    v_sub_u32 v32, v2, v28
    v_mul_u32_u24 v4, 5, v4
    v_add_u32 v4, v4, v32
    v_lshlrev_b32 v4, 4, v4
    v_add_u32 v6, s60, v4
    v_add_u32 v4, 48, v1
    v_mul_u32_u24 v28, 205, v4
    v_lshrrev_b32 v28, 12, v28
    v_mul_u32_u24 v28, 5, v28
    v_sub_u32 v33, v2, v28
    v_mul_u32_u24 v4, 5, v4
    v_add_u32 v4, v4, v33
    v_lshlrev_b32 v4, 4, v4
    v_add_u32 v7, s60, v4
    v_add_u32 v28, 0, v31
    v_add_u32 v29, 0, v5
    v_cmp_gt_u32 vcc, 5, v28
    s_nop 1
    v_cndmask_b32 v208, v30, v29, vcc
    v_add_u32 v28, 2, v31
    v_add_u32 v29, 32, v5
    v_cmp_gt_u32 vcc, 5, v28
    s_nop 1
    v_cndmask_b32 v209, v30, v29, vcc
    v_add_u32 v28, 4, v31
    v_add_u32 v29, 64, v5
    v_cmp_gt_u32 vcc, 5, v28
    s_nop 1
    v_cndmask_b32 v210, v30, v29, vcc
    v_add_u32 v28, 0, v32
    v_add_u32 v29, 0, v6
    v_cmp_gt_u32 vcc, 5, v28
    s_nop 1
    v_cndmask_b32 v211, v30, v29, vcc
    v_add_u32 v28, 2, v32
    v_add_u32 v29, 32, v6
    v_cmp_gt_u32 vcc, 5, v28
    s_nop 1
    v_cndmask_b32 v212, v30, v29, vcc
    v_add_u32 v28, 4, v32
    v_add_u32 v29, 64, v6
    v_cmp_gt_u32 vcc, 5, v28
    s_nop 1
    v_cndmask_b32 v213, v30, v29, vcc
    v_add_u32 v28, 6, v32
    v_add_u32 v29, 96, v6
    v_cmp_gt_u32 vcc, 5, v28
    s_nop 1
    v_cndmask_b32 v214, v30, v29, vcc
    v_add_u32 v28, 8, v32
    v_add_u32 v29, 128, v6
    v_cmp_gt_u32 vcc, 5, v28
    s_nop 1
    v_cndmask_b32 v215, v30, v29, vcc
    v_add_u32 v28, 10, v32
    v_add_u32 v29, 160, v6
    v_cmp_gt_u32 vcc, 5, v28
    s_nop 1
    v_cndmask_b32 v216, v30, v29, vcc
    v_add_u32 v28, 12, v32
    v_add_u32 v29, 192, v6
    v_cmp_gt_u32 vcc, 5, v28
    s_nop 1
    v_cndmask_b32 v217, v30, v29, vcc
    v_add_u32 v28, 14, v32
    v_add_u32 v29, 224, v6
    v_cmp_gt_u32 vcc, 5, v28
    s_nop 1
    v_cndmask_b32 v218, v30, v29, vcc
    v_add_u32 v28, 10, v33
    v_add_u32 v29, 160, v7
    v_cmp_gt_u32 vcc, 5, v28
    s_nop 1
    v_cndmask_b32 v219, v30, v29, vcc
    v_add_u32 v28, 12, v33
    v_add_u32 v29, 192, v7
    v_cmp_gt_u32 vcc, 5, v28
    s_nop 1
    v_cndmask_b32 v220, v30, v29, vcc
    v_add_u32 v28, 14, v33
    v_add_u32 v29, 224, v7
    v_cmp_gt_u32 vcc, 5, v28
    s_nop 1
    v_cndmask_b32 v221, v30, v29, vcc
    v_add_u32 v28, 16, v33
    v_add_u32 v29, 256, v7
    v_cmp_gt_u32 vcc, 5, v28
    s_nop 1
    v_cndmask_b32 v222, v30, v29, vcc
    v_add_u32 v28, 18, v33
    v_add_u32 v29, 288, v7
    v_cmp_gt_u32 vcc, 5, v28
    s_nop 1
    v_cndmask_b32 v223, v30, v29, vcc
    v_lshlrev_b32 v226, 4, v2
    v_add_u32 v226, s60, v226
    v_mov_b32 v228, s64
    v_cmp_gt_u32 vcc, 16, v1
    s_nop 1
    v_cndmask_b32 v228, 0, v228, vcc
    v_mov_b32 v229, v228
    s_lshl_b32 s60, s3, 7
    s_add_u32 s60, s60, 161920
    v_lshlrev_b32 v230, 4, v2
    v_add_u32 v230, s60, v230
    v_lshlrev_b32 v231, 2, v1
    v_add_u32 v231, 159744, v231
    v_lshlrev_b32 v232, 2, v27
    v_add_u32 v233, 5120, v232
    v_add_u32 v227, 84992, v232
    s_add_u32 s60, s70, 0
    v_add_u32 v20, s60, v16
    v_add_u32 v17, s70, v10
    s_barrier
    ds_read_b128 v[36:39], v17
    ds_read_b64_tr_b16 v[56:57], v20 offset:4288
    ds_read_b64_tr_b16 v[58:59], v20 offset:5568
    ds_read_b64_tr_b16 v[60:61], v20 offset:4352
    ds_read_b64_tr_b16 v[62:63], v20 offset:5632
    ds_read_b64_tr_b16 v[52:53], v20 offset:4224
    ds_read_b64_tr_b16 v[54:55], v20 offset:5504
    ds_read_b64_tr_b16 v[44:45], v20 offset:4096
    ds_read_b64_tr_b16 v[46:47], v20 offset:5376
L_main_A:
    s_waitcnt lgkmcnt(4)
    v_mfma_f32_32x32x16_bf16 v[144:159], v[36:39], v[56:59], v[144:159]
    ds_read_b64_tr_b16 v[48:49], v20 offset:4160
    ds_read_b64_tr_b16 v[50:51], v20 offset:5440
    s_add_u32 s60, s70, 39936
    v_add_u32 v20, s60, v16
    v_add_u32 v17, s70, v11
    ds_read_b128 v[40:43], v17
    v_mfma_f32_32x32x16_bf16 v[160:175], v[36:39], v[60:63], v[160:175]
    ds_read_b64_tr_b16 v[56:57], v20 offset:4288
    ds_read_b64_tr_b16 v[58:59], v20 offset:5568
    s_waitcnt lgkmcnt(5)
    v_mfma_f32_32x32x16_bf16 v[128:143], v[36:39], v[52:55], v[128:143]
    ds_read_b64_tr_b16 v[60:61], v20 offset:4352
    ds_read_b64_tr_b16 v[62:63], v20 offset:5632
    v_mfma_f32_32x32x16_bf16 v[96:111], v[36:39], v[44:47], v[96:111]
    ds_read_b64_tr_b16 v[52:53], v20 offset:4224
    ds_read_b64_tr_b16 v[54:55], v20 offset:5504
    s_waitcnt lgkmcnt(7)
    v_mfma_f32_32x32x16_bf16 v[112:127], v[36:39], v[48:51], v[112:127]
    ds_read_b64_tr_b16 v[44:45], v20 offset:4096
    ds_read_b64_tr_b16 v[46:47], v20 offset:5376
    s_waitcnt lgkmcnt(4)
    v_mfma_f32_32x32x16_bf16 v[144:159], v[40:43], v[56:59], v[144:159]
    ds_read_b64_tr_b16 v[48:49], v20 offset:4160
    ds_read_b64_tr_b16 v[50:51], v20 offset:5440
    s_add_u32 s60, s70, 79872
    v_add_u32 v20, s60, v16
    v_add_u32 v17, s70, v12
    ds_read_b128 v[36:39], v17
    v_mfma_f32_32x32x16_bf16 v[160:175], v[40:43], v[60:63], v[160:175]
    ds_read_b64_tr_b16 v[56:57], v20 offset:4288
    ds_read_b64_tr_b16 v[58:59], v20 offset:5568
    s_waitcnt lgkmcnt(5)
    v_mfma_f32_32x32x16_bf16 v[128:143], v[40:43], v[52:55], v[128:143]
    ds_read_b64_tr_b16 v[60:61], v20 offset:4352
    ds_read_b64_tr_b16 v[62:63], v20 offset:5632
    v_mfma_f32_32x32x16_bf16 v[96:111], v[40:43], v[44:47], v[96:111]
    ds_read_b64_tr_b16 v[52:53], v20 offset:4224
    ds_read_b64_tr_b16 v[54:55], v20 offset:5504
    s_waitcnt lgkmcnt(7)
    v_mfma_f32_32x32x16_bf16 v[112:127], v[40:43], v[48:51], v[112:127]
    ds_read_b64_tr_b16 v[44:45], v20 offset:4096
    ds_read_b64_tr_b16 v[46:47], v20 offset:5376
    s_waitcnt lgkmcnt(4)
    v_mfma_f32_32x32x16_bf16 v[144:159], v[36:39], v[56:59], v[144:159]
    ds_read_b64_tr_b16 v[48:49], v20 offset:4160
    ds_read_b64_tr_b16 v[50:51], v20 offset:5440
    s_add_u32 s60, s70, 119808
    v_add_u32 v20, s60, v16
    v_add_u32 v17, s70, v13
    ds_read_b128 v[40:43], v17
    v_mfma_f32_32x32x16_bf16 v[160:175], v[36:39], v[60:63], v[160:175]
    ds_read_b64_tr_b16 v[56:57], v20 offset:4288
    ds_read_b64_tr_b16 v[58:59], v20 offset:5568
    s_waitcnt lgkmcnt(5)
    v_mfma_f32_32x32x16_bf16 v[128:143], v[36:39], v[52:55], v[128:143]
    ds_read_b64_tr_b16 v[60:61], v20 offset:4352
    ds_read_b64_tr_b16 v[62:63], v20 offset:5632
    v_mfma_f32_32x32x16_bf16 v[96:111], v[36:39], v[44:47], v[96:111]
    ds_read_b64_tr_b16 v[52:53], v20 offset:4224
    ds_read_b64_tr_b16 v[54:55], v20 offset:5504
    s_waitcnt lgkmcnt(7)
    v_mfma_f32_32x32x16_bf16 v[112:127], v[36:39], v[48:51], v[112:127]
    ds_read_b64_tr_b16 v[44:45], v20 offset:4096
    ds_read_b64_tr_b16 v[46:47], v20 offset:5376
    s_waitcnt lgkmcnt(6)
    v_mfma_f32_32x32x16_bf16 v[144:159], v[40:43], v[56:59], v[144:159]
    ds_read_b64_tr_b16 v[48:49], v20 offset:4160
    ds_read_b64_tr_b16 v[50:51], v20 offset:5440
    s_add_u32 s60, s71, 0
    v_add_u32 v20, s60, v16
    v_add_u32 v17, s71, v10
    s_waitcnt lgkmcnt(6)
    v_mfma_f32_32x32x16_bf16 v[160:175], v[40:43], v[60:63], v[160:175]
    s_waitcnt lgkmcnt(0)
    s_barrier
    s_cmp_eq_u32 s72, 9
    s_cbranch_scc1 L_last_A
    ds_read_b128 v[36:39], v17
    ds_read_b64_tr_b16 v[56:57], v20 offset:4288
    ds_read_b64_tr_b16 v[58:59], v20 offset:5568
    v_mfma_f32_32x32x16_bf16 v[128:143], v[40:43], v[52:55], v[128:143]
    ds_read_b64_tr_b16 v[60:61], v20 offset:4352
    ds_read_b64_tr_b16 v[62:63], v20 offset:5632
    v_mfma_f32_32x32x16_bf16 v[96:111], v[40:43], v[44:47], v[96:111]
    ds_read_b64_tr_b16 v[52:53], v20 offset:4224
    ds_read_b64_tr_b16 v[54:55], v20 offset:5504
    v_mfma_f32_32x32x16_bf16 v[112:127], v[40:43], v[48:51], v[112:127]
    ds_read_b64_tr_b16 v[44:45], v20 offset:4096
    ds_read_b64_tr_b16 v[46:47], v20 offset:5376
    s_mov_b32 s70, s71
    s_add_u32 s71, s71, 13312
    s_cmp_ge_u32 s71, 39936
    s_cselect_b32 s71, 0, s71
    s_add_u32 s72, s72, 1
    s_branch L_main_A
L_last_A:
    ds_read_b32 v28, v231 offset:0
    ds_read_b32 v30, v231 offset:128
    ds_read_b32 v32, v231 offset:256
    ds_read_b32 v34, v231 offset:384
    ds_read_b32 v88, v231 offset:512
    ds_read_b128 v[234:237], v230 offset:512
    ds_read_b128 v[238:241], v230 offset:544
    ds_read_b128 v[242:245], v230 offset:576
    ds_read_b128 v[246:249], v230 offset:608
    ds_read_b128 v[72:75], v230 offset:0
    ds_read_b128 v[76:79], v230 offset:32
    ds_read_b128 v[80:83], v230 offset:64
    ds_read_b128 v[84:87], v230 offset:96
    v_mfma_f32_32x32x16_bf16 v[128:143], v[40:43], v[52:55], v[128:143]
    v_mfma_f32_32x32x16_bf16 v[96:111], v[40:43], v[44:47], v[96:111]
    v_mfma_f32_32x32x16_bf16 v[112:127], v[40:43], v[48:51], v[112:127]
    v_mov_b32 v92, s69
    v_mov_b32 v93, s69
    v_mov_b32 v94, s69
    v_mov_b32 v95, s69
    s_waitcnt lgkmcnt(0)
    v_pk_fma_f32 v[144:145], v[234:235], v[34:35], v[144:145] op_sel_hi:[1,0,1] neg_lo:[1,0,0] neg_hi:[1,0,0]
    v_pk_fma_f32 v[146:147], v[236:237], v[34:35], v[146:147] op_sel_hi:[1,0,1] neg_lo:[1,0,0] neg_hi:[1,0,0]
    v_pk_fma_f32 v[148:149], v[238:239], v[34:35], v[148:149] op_sel_hi:[1,0,1] neg_lo:[1,0,0] neg_hi:[1,0,0]
    v_pk_fma_f32 v[150:151], v[240:241], v[34:35], v[150:151] op_sel_hi:[1,0,1] neg_lo:[1,0,0] neg_hi:[1,0,0]
    v_pk_fma_f32 v[152:153], v[242:243], v[34:35], v[152:153] op_sel_hi:[1,0,1] neg_lo:[1,0,0] neg_hi:[1,0,0]
    v_pk_fma_f32 v[154:155], v[244:245], v[34:35], v[154:155] op_sel_hi:[1,0,1] neg_lo:[1,0,0] neg_hi:[1,0,0]
    v_pk_fma_f32 v[156:157], v[246:247], v[34:35], v[156:157] op_sel_hi:[1,0,1] neg_lo:[1,0,0] neg_hi:[1,0,0]
    v_pk_fma_f32 v[158:159], v[248:249], v[34:35], v[158:159] op_sel_hi:[1,0,1] neg_lo:[1,0,0] neg_hi:[1,0,0]
    v_pk_mul_f32 v[144:145], v[144:145], v[72:73]
    v_pk_mul_f32 v[146:147], v[146:147], v[74:75]
    v_pk_mul_f32 v[148:149], v[148:149], v[76:77]
    v_pk_mul_f32 v[150:151], v[150:151], v[78:79]
    v_pk_mul_f32 v[152:153], v[152:153], v[80:81]
    v_pk_mul_f32 v[154:155], v[154:155], v[82:83]
    v_pk_mul_f32 v[156:157], v[156:157], v[84:85]
    v_pk_mul_f32 v[158:159], v[158:159], v[86:87]
    v_cvt_pk_bf16_f32 v144, v144, v145
    v_cvt_pk_bf16_f32 v145, v146, v147
    v_cvt_pk_bf16_f32 v146, v148, v149
    v_cvt_pk_bf16_f32 v147, v150, v151
    v_cvt_pk_bf16_f32 v148, v152, v153
    v_cvt_pk_bf16_f32 v149, v154, v155
    v_cvt_pk_bf16_f32 v150, v156, v157
    v_cvt_pk_bf16_f32 v151, v158, v159
    v_pk_fma_f32 v[160:161], v[234:235], v[88:89], v[160:161] op_sel_hi:[1,0,1] neg_lo:[1,0,0] neg_hi:[1,0,0]
    v_pk_fma_f32 v[162:163], v[236:237], v[88:89], v[162:163] op_sel_hi:[1,0,1] neg_lo:[1,0,0] neg_hi:[1,0,0]
    v_pk_fma_f32 v[164:165], v[238:239], v[88:89], v[164:165] op_sel_hi:[1,0,1] neg_lo:[1,0,0] neg_hi:[1,0,0]
    v_pk_fma_f32 v[166:167], v[240:241], v[88:89], v[166:167] op_sel_hi:[1,0,1] neg_lo:[1,0,0] neg_hi:[1,0,0]
    v_pk_fma_f32 v[168:169], v[242:243], v[88:89], v[168:169] op_sel_hi:[1,0,1] neg_lo:[1,0,0] neg_hi:[1,0,0]
    v_pk_fma_f32 v[170:171], v[244:245], v[88:89], v[170:171] op_sel_hi:[1,0,1] neg_lo:[1,0,0] neg_hi:[1,0,0]
    v_pk_fma_f32 v[172:173], v[246:247], v[88:89], v[172:173] op_sel_hi:[1,0,1] neg_lo:[1,0,0] neg_hi:[1,0,0]
    v_pk_fma_f32 v[174:175], v[248:249], v[88:89], v[174:175] op_sel_hi:[1,0,1] neg_lo:[1,0,0] neg_hi:[1,0,0]
    v_pk_mul_f32 v[160:161], v[160:161], v[72:73]
    v_pk_mul_f32 v[162:163], v[162:163], v[74:75]
    v_pk_mul_f32 v[164:165], v[164:165], v[76:77]
    v_pk_mul_f32 v[166:167], v[166:167], v[78:79]
    v_pk_mul_f32 v[168:169], v[168:169], v[80:81]
    v_pk_mul_f32 v[170:171], v[170:171], v[82:83]
    v_pk_mul_f32 v[172:173], v[172:173], v[84:85]
    v_pk_mul_f32 v[174:175], v[174:175], v[86:87]
    v_cvt_pk_bf16_f32 v160, v160, v161
    v_cvt_pk_bf16_f32 v161, v162, v163
    v_cvt_pk_bf16_f32 v162, v164, v165
    v_cvt_pk_bf16_f32 v163, v166, v167
    v_cvt_pk_bf16_f32 v164, v168, v169
    v_cvt_pk_bf16_f32 v165, v170, v171
    v_cvt_pk_bf16_f32 v166, v172, v173
    v_cvt_pk_bf16_f32 v167, v174, v175
    v_pk_fma_f32 v[128:129], v[234:235], v[32:33], v[128:129] op_sel_hi:[1,0,1] neg_lo:[1,0,0] neg_hi:[1,0,0]
    v_pk_fma_f32 v[130:131], v[236:237], v[32:33], v[130:131] op_sel_hi:[1,0,1] neg_lo:[1,0,0] neg_hi:[1,0,0]
    v_pk_fma_f32 v[132:133], v[238:239], v[32:33], v[132:133] op_sel_hi:[1,0,1] neg_lo:[1,0,0] neg_hi:[1,0,0]
    v_pk_fma_f32 v[134:135], v[240:241], v[32:33], v[134:135] op_sel_hi:[1,0,1] neg_lo:[1,0,0] neg_hi:[1,0,0]
    v_pk_fma_f32 v[136:137], v[242:243], v[32:33], v[136:137] op_sel_hi:[1,0,1] neg_lo:[1,0,0] neg_hi:[1,0,0]
    v_pk_fma_f32 v[138:139], v[244:245], v[32:33], v[138:139] op_sel_hi:[1,0,1] neg_lo:[1,0,0] neg_hi:[1,0,0]
    v_pk_fma_f32 v[140:141], v[246:247], v[32:33], v[140:141] op_sel_hi:[1,0,1] neg_lo:[1,0,0] neg_hi:[1,0,0]
    v_pk_fma_f32 v[142:143], v[248:249], v[32:33], v[142:143] op_sel_hi:[1,0,1] neg_lo:[1,0,0] neg_hi:[1,0,0]
    v_pk_fma_f32 v[128:129], v[128:129], v[72:73], v[228:229]
    v_pk_fma_f32 v[130:131], v[130:131], v[74:75], v[228:229]
    v_pk_fma_f32 v[132:133], v[132:133], v[76:77], v[228:229]
    v_pk_fma_f32 v[134:135], v[134:135], v[78:79], v[228:229]
    v_pk_fma_f32 v[136:137], v[136:137], v[80:81], v[228:229]
    v_pk_fma_f32 v[138:139], v[138:139], v[82:83], v[228:229]
    v_pk_fma_f32 v[140:141], v[140:141], v[84:85], v[228:229]
    v_pk_fma_f32 v[142:143], v[142:143], v[86:87], v[228:229]
    v_cvt_pk_bf16_f32 v60, v128, v129
    v_cvt_pk_bf16_f32 v61, v130, v131
    v_cvt_pk_bf16_f32 v62, v132, v133
    v_cvt_pk_bf16_f32 v63, v134, v135
    v_cvt_pk_bf16_f32 v64, v136, v137
    v_cvt_pk_bf16_f32 v65, v138, v139
    v_cvt_pk_bf16_f32 v66, v140, v141
    v_cvt_pk_bf16_f32 v67, v142, v143
    v_pk_mul_f32 v[44:45], v[128:129], s[52:53]
    v_pk_mul_f32 v[46:47], v[130:131], s[52:53]
    v_pk_mul_f32 v[48:49], v[132:133], s[52:53]
    v_pk_mul_f32 v[50:51], v[134:135], s[52:53]
    v_pk_mul_f32 v[52:53], v[136:137], s[52:53]
    v_pk_mul_f32 v[54:55], v[138:139], s[52:53]
    v_pk_mul_f32 v[56:57], v[140:141], s[52:53]
    v_pk_mul_f32 v[58:59], v[142:143], s[52:53]
    v_exp_f32_e64 v44, v44 clamp
    v_max_f32 v128, s64, v128
    v_exp_f32_e64 v45, v45 clamp
    v_max_f32 v129, s64, v129
    v_exp_f32_e64 v46, v46 clamp
    v_max_f32 v130, s64, v130
    v_exp_f32_e64 v47, v47 clamp
    v_max_f32 v131, s64, v131
    v_exp_f32_e64 v48, v48 clamp
    v_max_f32 v132, s64, v132
    v_exp_f32_e64 v49, v49 clamp
    v_max_f32 v133, s64, v133
    v_exp_f32_e64 v50, v50 clamp
    v_max_f32 v134, s64, v134
    v_exp_f32_e64 v51, v51 clamp
    v_max_f32 v135, s64, v135
    v_exp_f32_e64 v52, v52 clamp
    v_max_f32 v136, s64, v136
    v_exp_f32_e64 v53, v53 clamp
    v_max_f32 v137, s64, v137
    v_exp_f32_e64 v54, v54 clamp
    v_max_f32 v138, s64, v138
    v_exp_f32_e64 v55, v55 clamp
    v_max_f32 v139, s64, v139
    v_exp_f32_e64 v56, v56 clamp
    v_max_f32 v140, s64, v140
    v_exp_f32_e64 v57, v57 clamp
    v_max_f32 v141, s64, v141
    v_exp_f32_e64 v58, v58 clamp
    v_max_f32 v142, s64, v142
    v_exp_f32_e64 v59, v59 clamp
    v_max_f32 v143, s64, v143
    v_pk_add_f32 v[128:129], v[128:129], v[44:45]
    v_pk_add_f32 v[130:131], v[130:131], v[46:47]
    v_pk_add_f32 v[132:133], v[132:133], v[48:49]
    v_pk_add_f32 v[134:135], v[134:135], v[50:51]
    v_pk_add_f32 v[136:137], v[136:137], v[52:53]
    v_pk_add_f32 v[138:139], v[138:139], v[54:55]
    v_pk_add_f32 v[140:141], v[140:141], v[56:57]
    v_pk_add_f32 v[142:143], v[142:143], v[58:59]
    v_cvt_pk_bf16_f32 v128, v128, v129
    v_cvt_pk_bf16_f32 v129, v130, v131
    v_cvt_pk_bf16_f32 v130, v132, v133
    v_cvt_pk_bf16_f32 v131, v134, v135
    v_cvt_pk_bf16_f32 v132, v136, v137
    v_cvt_pk_bf16_f32 v133, v138, v139
    v_cvt_pk_bf16_f32 v134, v140, v141
    v_cvt_pk_bf16_f32 v135, v142, v143
    v_pk_fma_f32 v[96:97], v[234:235], v[28:29], v[96:97] op_sel_hi:[1,0,1] neg_lo:[1,0,0] neg_hi:[1,0,0]
    v_pk_fma_f32 v[98:99], v[236:237], v[28:29], v[98:99] op_sel_hi:[1,0,1] neg_lo:[1,0,0] neg_hi:[1,0,0]
    v_pk_fma_f32 v[100:101], v[238:239], v[28:29], v[100:101] op_sel_hi:[1,0,1] neg_lo:[1,0,0] neg_hi:[1,0,0]
    v_mfma_f32_32x32x16_bf16 v[176:191], v[128:131], v[160:163], 0
    v_pk_fma_f32 v[102:103], v[240:241], v[28:29], v[102:103] op_sel_hi:[1,0,1] neg_lo:[1,0,0] neg_hi:[1,0,0]
    v_pk_fma_f32 v[104:105], v[242:243], v[28:29], v[104:105] op_sel_hi:[1,0,1] neg_lo:[1,0,0] neg_hi:[1,0,0]
    v_pk_fma_f32 v[106:107], v[244:245], v[28:29], v[106:107] op_sel_hi:[1,0,1] neg_lo:[1,0,0] neg_hi:[1,0,0]
    v_pk_fma_f32 v[108:109], v[246:247], v[28:29], v[108:109] op_sel_hi:[1,0,1] neg_lo:[1,0,0] neg_hi:[1,0,0]
    v_pk_fma_f32 v[110:111], v[248:249], v[28:29], v[110:111] op_sel_hi:[1,0,1] neg_lo:[1,0,0] neg_hi:[1,0,0]
    v_pk_fma_f32 v[96:97], v[96:97], v[72:73], s[74:75]
    v_pk_fma_f32 v[98:99], v[98:99], v[74:75], s[74:75]
    v_pk_fma_f32 v[100:101], v[100:101], v[76:77], s[74:75]
    v_mfma_f32_32x32x16_bf16 v[176:191], v[132:135], v[164:167], v[176:191]
    v_pk_fma_f32 v[102:103], v[102:103], v[78:79], s[74:75]
    v_pk_fma_f32 v[104:105], v[104:105], v[80:81], s[74:75]
    v_pk_fma_f32 v[106:107], v[106:107], v[82:83], s[74:75]
    v_pk_fma_f32 v[108:109], v[108:109], v[84:85], s[74:75]
    v_pk_fma_f32 v[110:111], v[110:111], v[86:87], s[74:75]
    v_pk_mul_f32 v[44:45], v[96:97], s[52:53]
    v_pk_mul_f32 v[46:47], v[98:99], s[52:53]
    v_pk_mul_f32 v[48:49], v[100:101], s[52:53]
    v_mfma_f32_32x32x16_bf16 v[192:207], v[128:131], v[92:95], 0
    v_pk_mul_f32 v[50:51], v[102:103], s[52:53]
    v_pk_mul_f32 v[52:53], v[104:105], s[52:53]
    v_pk_mul_f32 v[54:55], v[106:107], s[52:53]
    v_pk_mul_f32 v[56:57], v[108:109], s[52:53]
    v_pk_mul_f32 v[58:59], v[110:111], s[52:53]
    v_exp_f32_e64 v44, v44 clamp
    v_max_f32 v96, s64, v96
    v_exp_f32_e64 v45, v45 clamp
    v_mfma_f32_32x32x16_bf16 v[192:207], v[132:135], v[92:95], v[192:207]
    v_max_f32 v97, s64, v97
    v_exp_f32_e64 v46, v46 clamp
    v_max_f32 v98, s64, v98
    v_exp_f32_e64 v47, v47 clamp
    v_max_f32 v99, s64, v99
    v_exp_f32_e64 v48, v48 clamp
    v_max_f32 v100, s64, v100
    v_exp_f32_e64 v49, v49 clamp
    v_max_f32 v101, s64, v101
    v_exp_f32_e64 v50, v50 clamp
    v_max_f32 v102, s64, v102
    v_exp_f32_e64 v51, v51 clamp
    v_max_f32 v103, s64, v103
    v_exp_f32_e64 v52, v52 clamp
    v_max_f32 v104, s64, v104
    v_exp_f32_e64 v53, v53 clamp
    v_max_f32 v105, s64, v105
    v_exp_f32_e64 v54, v54 clamp
    v_max_f32 v106, s64, v106
    v_exp_f32_e64 v55, v55 clamp
    v_max_f32 v107, s64, v107
    v_exp_f32_e64 v56, v56 clamp
    ds_write_b128 v222, v[176:179]
    v_max_f32 v108, s64, v108
    v_exp_f32_e64 v57, v57 clamp
    v_max_f32 v109, s64, v109
    v_exp_f32_e64 v58, v58 clamp
    ds_write_b128 v223, v[180:183]
    v_max_f32 v110, s64, v110
    v_exp_f32_e64 v59, v59 clamp
    v_max_f32 v111, s64, v111
    v_pk_add_f32 v[96:97], v[96:97], v[44:45]
    s_mov_b32 exec_lo, 1
    s_mov_b32 exec_hi, 1
    ds_write_b128 v226, v[192:195] offset:6656
    ds_write_b128 v226, v[196:199] offset:6688
    s_mov_b64 exec, -1
    v_pk_add_f32 v[98:99], v[98:99], v[46:47]
    v_pk_add_f32 v[100:101], v[100:101], v[48:49]
    v_pk_add_f32 v[102:103], v[102:103], v[50:51]
    v_pk_add_f32 v[104:105], v[104:105], v[52:53]
    v_pk_add_f32 v[106:107], v[106:107], v[54:55]
    v_pk_add_f32 v[108:109], v[108:109], v[56:57]
    v_pk_add_f32 v[110:111], v[110:111], v[58:59]
    v_cvt_pk_bf16_f32 v96, v96, v97
    v_cvt_pk_bf16_f32 v97, v98, v99
    v_cvt_pk_bf16_f32 v98, v100, v101
    v_cvt_pk_bf16_f32 v99, v102, v103
    v_cvt_pk_bf16_f32 v100, v104, v105
    v_cvt_pk_bf16_f32 v101, v106, v107
    v_cvt_pk_bf16_f32 v102, v108, v109
    v_cvt_pk_bf16_f32 v103, v110, v111
    v_pk_fma_f32 v[112:113], v[234:235], v[30:31], v[112:113] op_sel_hi:[1,0,1] neg_lo:[1,0,0] neg_hi:[1,0,0]
    v_pk_fma_f32 v[114:115], v[236:237], v[30:31], v[114:115] op_sel_hi:[1,0,1] neg_lo:[1,0,0] neg_hi:[1,0,0]
    v_pk_fma_f32 v[116:117], v[238:239], v[30:31], v[116:117] op_sel_hi:[1,0,1] neg_lo:[1,0,0] neg_hi:[1,0,0]
    v_mfma_f32_32x32x16_bf16 v[4:19], v[96:99], v[60:63], 0
    v_pk_fma_f32 v[118:119], v[240:241], v[30:31], v[118:119] op_sel_hi:[1,0,1] neg_lo:[1,0,0] neg_hi:[1,0,0]
    v_pk_fma_f32 v[120:121], v[242:243], v[30:31], v[120:121] op_sel_hi:[1,0,1] neg_lo:[1,0,0] neg_hi:[1,0,0]
    v_pk_fma_f32 v[122:123], v[244:245], v[30:31], v[122:123] op_sel_hi:[1,0,1] neg_lo:[1,0,0] neg_hi:[1,0,0]
    v_pk_fma_f32 v[124:125], v[246:247], v[30:31], v[124:125] op_sel_hi:[1,0,1] neg_lo:[1,0,0] neg_hi:[1,0,0]
    v_pk_fma_f32 v[126:127], v[248:249], v[30:31], v[126:127] op_sel_hi:[1,0,1] neg_lo:[1,0,0] neg_hi:[1,0,0]
    v_pk_fma_f32 v[112:113], v[112:113], v[72:73], s[74:75]
    v_pk_fma_f32 v[114:115], v[114:115], v[74:75], s[74:75]
    v_pk_fma_f32 v[116:117], v[116:117], v[76:77], s[74:75]
    v_mfma_f32_32x32x16_bf16 v[4:19], v[100:103], v[64:67], v[4:19]
    v_pk_fma_f32 v[118:119], v[118:119], v[78:79], s[74:75]
    v_pk_fma_f32 v[120:121], v[120:121], v[80:81], s[74:75]
    v_pk_fma_f32 v[122:123], v[122:123], v[82:83], s[74:75]
    v_pk_fma_f32 v[124:125], v[124:125], v[84:85], s[74:75]
    v_pk_fma_f32 v[126:127], v[126:127], v[86:87], s[74:75]
    v_pk_mul_f32 v[44:45], v[112:113], s[52:53]
    v_pk_mul_f32 v[46:47], v[114:115], s[52:53]
    v_pk_mul_f32 v[48:49], v[116:117], s[52:53]
    v_mfma_f32_32x32x16_bf16 v[176:191], v[96:99], v[144:147], 0
    v_pk_mul_f32 v[50:51], v[118:119], s[52:53]
    v_pk_mul_f32 v[52:53], v[120:121], s[52:53]
    v_pk_mul_f32 v[54:55], v[122:123], s[52:53]
    v_pk_mul_f32 v[56:57], v[124:125], s[52:53]
    v_pk_mul_f32 v[58:59], v[126:127], s[52:53]
    v_exp_f32_e64 v44, v44 clamp
    v_max_f32 v112, s64, v112
    v_exp_f32_e64 v45, v45 clamp
    v_mfma_f32_32x32x16_bf16 v[176:191], v[100:103], v[148:151], v[176:191]
    v_max_f32 v113, s64, v113
    v_exp_f32_e64 v46, v46 clamp
    v_max_f32 v114, s64, v114
    v_exp_f32_e64 v47, v47 clamp
    v_max_f32 v115, s64, v115
    v_exp_f32_e64 v48, v48 clamp
    v_max_f32 v116, s64, v116
    v_exp_f32_e64 v49, v49 clamp
    v_mfma_f32_32x32x16_bf16 v[192:207], v[96:99], v[92:95], 0
    v_max_f32 v117, s64, v117
    v_exp_f32_e64 v50, v50 clamp
    v_max_f32 v118, s64, v118
    v_exp_f32_e64 v51, v51 clamp
    v_max_f32 v119, s64, v119
    v_exp_f32_e64 v52, v52 clamp
    v_max_f32 v120, s64, v120
    v_exp_f32_e64 v53, v53 clamp
    v_mfma_f32_32x32x16_bf16 v[192:207], v[100:103], v[92:95], v[192:207]
    v_max_f32 v121, s64, v121
    v_exp_f32_e64 v54, v54 clamp
    v_max_f32 v122, s64, v122
    v_exp_f32_e64 v55, v55 clamp
    v_max_f32 v123, s64, v123
    v_exp_f32_e64 v56, v56 clamp
    v_max_f32 v124, s64, v124
    v_exp_f32_e64 v57, v57 clamp
    v_max_f32 v125, s64, v125
    v_exp_f32_e64 v58, v58 clamp
    v_max_f32 v126, s64, v126
    v_exp_f32_e64 v59, v59 clamp
    v_max_f32 v127, s64, v127
    v_pk_add_f32 v[112:113], v[112:113], v[44:45]
    v_pk_add_f32 v[114:115], v[114:115], v[46:47]
    v_pk_add_f32 v[116:117], v[116:117], v[48:49]
    ds_write_b128 v208, v[4:7]
    v_pk_add_f32 v[118:119], v[118:119], v[50:51]
    v_pk_add_f32 v[120:121], v[120:121], v[52:53]
    ds_write_b128 v209, v[8:11]
    v_pk_add_f32 v[122:123], v[122:123], v[54:55]
    v_pk_add_f32 v[124:125], v[124:125], v[56:57]
    ds_write_b128 v210, v[12:15]
    v_pk_add_f32 v[126:127], v[126:127], v[58:59]
    v_cvt_pk_bf16_f32 v112, v112, v113
    ds_write_b128 v211, v[176:179]
    v_cvt_pk_bf16_f32 v113, v114, v115
    v_cvt_pk_bf16_f32 v114, v116, v117
    ds_write_b128 v212, v[180:183]
    v_cvt_pk_bf16_f32 v115, v118, v119
    v_cvt_pk_bf16_f32 v116, v120, v121
    ds_write_b128 v213, v[184:187]
    v_cvt_pk_bf16_f32 v117, v122, v123
    v_cvt_pk_bf16_f32 v118, v124, v125
    ds_write_b128 v214, v[188:191]
    v_cvt_pk_bf16_f32 v119, v126, v127
    v_mfma_f32_32x32x16_bf16 v[234:249], v[112:115], v[144:147], 0
    s_nop 0
    v_mfma_f32_32x32x16_bf16 v[234:249], v[116:119], v[148:151], v[234:249]
    v_mfma_f32_32x32x16_bf16 v[72:87], v[112:115], v[160:163], 0
    v_mfma_f32_32x32x16_bf16 v[72:87], v[116:119], v[164:167], v[72:87]
    v_mfma_f32_32x32x16_bf16 v[44:59], v[112:115], v[92:95], 0
    v_mfma_f32_32x32x16_bf16 v[44:59], v[116:119], v[92:95], v[44:59]
    s_mov_b32 exec_lo, 1
    s_mov_b32 exec_hi, 1
    ds_write_b128 v226, v[192:195] offset:6400
    ds_write_b128 v226, v[196:199] offset:6432
    ds_write_b128 v226, v[200:203] offset:6464
    ds_write_b128 v226, v[204:207] offset:6496
    s_mov_b64 exec, -1
    s_nop 0
    ds_write_b128 v215, v[234:237]
    ds_write_b128 v216, v[238:241]
    ds_write_b128 v217, v[242:245]
    ds_write_b128 v218, v[246:249]
    ds_write_b128 v219, v[76:79]
    ds_write_b128 v220, v[80:83]
    ds_write_b128 v221, v[84:87]
    s_mov_b32 exec_lo, 1
    s_mov_b32 exec_hi, 1
    ds_write_b128 v226, v[44:47] offset:6528
    ds_write_b128 v226, v[48:51] offset:6560
    ds_write_b128 v226, v[52:55] offset:6592
    ds_write_b128 v226, v[56:59] offset:6624
    s_mov_b64 exec, -1
    s_waitcnt lgkmcnt(0)
    v_mov_b32 v90, 1
    s_mov_b64 exec, 1
    ds_add_u32 v26, v90 offset:4
    s_mov_b64 exec, -1
    s_lshl_b32 s63, s45, 13
    s_add_u32 s63, s63, 12582912
    s_mov_b32 s62, 0
L_sp_pw:
    ds_read_b32 v90, v26 offset:4
    s_waitcnt lgkmcnt(0)
    v_readfirstlane_b32 s60, v90
    s_nop 0
    s_cmp_ge_u32 s60, 4
    s_cbranch_scc1 L_spd_pw
    s_sleep 1
    s_add_u32 s62, s62, 1
    s_cmp_lt_u32 s62, 0x800000
    s_cbranch_scc1 L_sp_pw
L_spd_pw:
    ds_read_b32 v96, v233 offset:0
    ds_read_b32 v97, v233 offset:39936
    ds_read_b32 v98, v227 offset:0
    ds_read_b32 v99, v227 offset:39936
    ds_read_b32 v100, v233 offset:1024
    ds_read_b32 v101, v233 offset:40960
    ds_read_b32 v102, v227 offset:1024
    ds_read_b32 v103, v227 offset:40960
    ds_read_b32 v104, v233 offset:2048
    ds_read_b32 v105, v233 offset:41984
    ds_read_b32 v106, v227 offset:2048
    ds_read_b32 v107, v227 offset:41984
    s_waitcnt lgkmcnt(4)
    ds_read_b32 v108, v233 offset:3072
    ds_read_b32 v109, v233 offset:43008
    ds_read_b32 v110, v227 offset:3072
    ds_read_b32 v111, v227 offset:43008
    ds_read_b32 v112, v233 offset:4096
    ds_read_b32 v113, v233 offset:44032
    ds_read_b32 v114, v227 offset:4096
    ds_read_b32 v115, v227 offset:44032
    ds_read_b32 v116, v233 offset:5120
    ds_read_b32 v117, v233 offset:45056
    ds_read_b32 v118, v227 offset:5120
    ds_read_b32 v119, v227 offset:45056
    s_waitcnt lgkmcnt(4)
    ds_read_b32 v120, v233 offset:6144
    ds_read_b32 v121, v233 offset:46080
    ds_read_b32 v122, v227 offset:6144
    ds_read_b32 v123, v227 offset:46080
    v_cmp_gt_u32 s[60:61], 36, v27
    s_nop 0
    v_lshrrev_b32 v4, 2, v27
    v_cmp_gt_u32 s[60:61], 36, v4
    v_add_f32 v96, v96, v97
    v_add_f32 v98, v98, v99
    v_add_f32 v96, v96, v98
    buffer_atomic_add_f32 v96, v232, s[32:35], s63 offen offset:0
    v_add_f32 v100, v100, v101
    v_add_f32 v102, v102, v103
    v_add_f32 v100, v100, v102
    buffer_atomic_add_f32 v100, v232, s[32:35], s63 offen offset:1024
    v_add_f32 v104, v104, v105
    v_add_f32 v106, v106, v107
    v_add_f32 v104, v104, v106
    buffer_atomic_add_f32 v104, v232, s[32:35], s63 offen offset:2048
    v_add_f32 v108, v108, v109
    v_add_f32 v110, v110, v111
    v_add_f32 v108, v108, v110
    buffer_atomic_add_f32 v108, v232, s[32:35], s63 offen offset:3072
    v_add_f32 v112, v112, v113
    v_add_f32 v114, v114, v115
    v_add_f32 v112, v112, v114
    s_add_u32 s63, s63, 4096
    buffer_atomic_add_f32 v112, v232, s[32:35], s63 offen offset:0
    s_waitcnt lgkmcnt(4)
    v_add_f32 v116, v116, v117
    v_add_f32 v118, v118, v119
    v_add_f32 v116, v116, v118
    buffer_atomic_add_f32 v116, v232, s[32:35], s63 offen offset:1024
    s_waitcnt lgkmcnt(0)
    v_add_f32 v120, v120, v121
    v_add_f32 v122, v122, v123
    v_add_f32 v120, v120, v122
    s_mov_b64 exec, s[60:61]
    buffer_atomic_add_f32 v120, v232, s[32:35], s63 offen offset:2048
    s_mov_b64 exec, -1
    s_waitcnt vmcnt(0)
    v_mov_b32 v90, 1
    s_mov_b64 exec, 1
    ds_add_rtn_u32 v91, v26, v90 offset:8
    s_mov_b64 exec, -1
    s_waitcnt lgkmcnt(0)
    v_readfirstlane_b32 s60, v91
    s_nop 0
    s_cmp_eq_u32 s60, 3
    s_cbranch_scc0 L_cA_end
    v_lshlrev_b32 v1, 10, v0
    v_mov_b32 v3, 1
    s_lshl_b32 s61, s45, 7
    s_lshl_b32 s60, s44, 2
    s_add_u32 s61, s61, s60
    s_add_u32 s61, s61, 14057472
    s_mov_b64 exec, 0xffff
    buffer_store_dword v3, v1, s[32:35], s61 offen sc1
    s_mov_b64 exec, -1
L_cA_end:
    s_endpgm
L_exit:
    s_endpgm
.section .rodata,"a"
.p2align 6
.amdhsa_kernel parallel_sum__linear_attn_block__dense_activation_relu__prompt_kernel
  .amdhsa_next_free_vgpr 256
  .amdhsa_next_free_sgpr 102
  .amdhsa_accum_offset 256
  .amdhsa_group_segment_fixed_size 0
  .amdhsa_kernarg_size 72
  .amdhsa_user_sgpr_count 2
  .amdhsa_user_sgpr_kernarg_segment_ptr 1
  .amdhsa_system_sgpr_workgroup_id_x 1
.end_amdhsa_kernel
```
